```python
import torch

def _softmax(x, axis=-1):
    return torch.softmax(x, dim=axis)
def _gelu(x):
    return torch.nn.functional.gelu(x, approximate="tanh")
def _silu(x):
    return torch.nn.functional.silu(x)
def _sigmoid(x):
    return torch.sigmoid(x)
def _layernorm(x, axis=-1, eps=1e-5):
    m = x.mean(dim=axis, keepdim=True)
    v = x.var(dim=axis, keepdim=True, unbiased=False)
    return (x - m) / torch.sqrt(v + eps)
def _scatter_add(tgt, idx, src, axis=0):
    return tgt.clone().index_add_(axis, idx, src)
def _segment_sum(src, seg, n):
    out = torch.zeros((n,) + src.shape[1:], dtype=src.dtype)
    return out.index_add_(0, seg, src)
def _pad(x, pw):
    flat = tuple(v for pair in reversed(pw) for v in pair)
    return torch.nn.functional.pad(x, flat)

kernel_name = 'parallel_sum__ssm_conv_s4__dense_activation_relu__prompt'

def setup_inputs():

    _w = (lambda a: (lambda t: t.to(torch.bfloat16) if t.is_floating_point() else t)(torch.as_tensor(a)))
    def _A_setup():
        B, L, D, N = 1, 2048, 512, 128
        A_re = -(lambda _x: torch.exp(torch.as_tensor(_x)))((lambda *s: torch.randn(*s, dtype=torch.bfloat16) * 3.2)(D, N))
        A_im = torch.pi * (lambda *s: torch.randn(*s, dtype=torch.bfloat16) * 0.1)(D, N)
        B_re = (lambda *s: torch.randn(*s, dtype=torch.bfloat16) * 0.4)(D, N)
        B_im = (lambda *s: torch.randn(*s, dtype=torch.bfloat16) * 0.4)(D, N)
        C_re = (lambda *s: torch.randn(*s, dtype=torch.bfloat16) * 0.4)(D, N)
        C_im = (lambda *s: torch.randn(*s, dtype=torch.bfloat16) * 0.4)(D, N)
        log_dt = (lambda *s: torch.randn(*s, dtype=torch.bfloat16) * 0.1)(D) * 0.5 - 4.0
        Dskip = (lambda *s: torch.randn(*s, dtype=torch.bfloat16) * 0.2)(D)
        return {
            "u": _w((lambda *s: torch.randn(*s, dtype=torch.bfloat16) * 0.05)(B, L, D)),
            "A_re": _w(A_re),
            "A_im": _w(A_im),
            "B_re": _w(B_re),
            "B_im": _w(B_im),
            "C_re": _w(C_re),
            "C_im": _w(C_im),
            "log_dt": _w(log_dt),
            "Dskip": _w(Dskip),
        }
    _A_in = _A_setup()

    def _B_setup():
        B, S, D, Dff = 1, 2048, 512, 1376
        return {
            "x": _w((lambda *s: torch.randn(*s, dtype=torch.bfloat16) * 0.05)(B, S, D)),
            "w1": _w((lambda *s: torch.randn(*s, dtype=torch.bfloat16) * 0.05)(D, Dff)),
            "w2": _w((lambda *s: torch.randn(*s, dtype=torch.bfloat16) * 0.05)(Dff, D)),
        }
    _B_in = _B_setup()

    return {
        "A_u": _A_in["u"],
        "A_A_re": _A_in["A_re"],
        "A_A_im": _A_in["A_im"],
        "A_B_re": _A_in["B_re"],
        "A_B_im": _A_in["B_im"],
        "A_C_re": _A_in["C_re"],
        "A_C_im": _A_in["C_im"],
        "A_log_dt": _A_in["log_dt"],
        "A_Dskip": _A_in["Dskip"],
        "B_x": _B_in["x"],
        "B_w1": _B_in["w1"],
        "B_w2": _B_in["w2"],
    }

def reference(A_u, A_A_re, A_A_im, A_B_re, A_B_im, A_C_re, A_C_im, A_log_dt, A_Dskip, B_x, B_w1, B_w2):
    def _A_ref(u, A_re, A_im, B_re, B_im, C_re, C_im, log_dt, Dskip):
        Bsz, L, D = u.shape
        dt = torch.exp(log_dt)[:, None]
        A = A_re + 1j * A_im
        Bc = B_re + 1j * B_im
        Cc = C_re + 1j * C_im
        logdA = dt * A
        dB = dt * Bc
        l = (lambda x, dt: x.to(dt))(torch.arange(L), A_re.dtype)
        P = torch.exp(logdA[:, :, None] * l[None, None, :])
        K = torch.einsum("dn,dnl,dn->dl", Cc, P, dB).real
        L2 = 2 * L
        Kp = _pad(K, ((0, 0), (0, L)))
        up = (lambda x, *d: x.permute(*d))(u, 0, 2, 1)
        up = _pad(up, ((0, 0), (0, 0), (0, L)))
        Kf = (lambda x, axes=(-2,-1): torch.fft.rfft2(x.float(), dim=axes))(Kp[:, None, :], axes=(-2, -1))
        Uf = (lambda x, axes=(-2,-1): torch.fft.rfft2(x.float(), dim=axes))(up[:, :, None, :], axes=(-2, -1))
        Yf = Uf * Kf[None, :, :, :]
        y = (lambda x, s, axes=(-2,-1): torch.fft.irfft2(x, s=s, dim=axes).to(torch.bfloat16))(Yf, (1, L2), axes=(-2, -1))[:, :, 0, :L]
        y = (lambda x, *d: x.permute(*d))(y, 0, 2, 1) + u * Dskip[None, None, :]
        return y

    def _B_ref(x, w1, w2):
        h = torch.einsum("bsd,df->bsf", x, w1)
        zero = torch.zeros_like(h)
        h = torch.maximum(h, zero)
        return torch.einsum("bsf,fd->bsd", h, w2)

    x = A_u
    xn = _layernorm(x, axis=-1)
    return x + _A_ref(xn, A_A_re, A_A_im, A_B_re, A_B_im, A_C_re, A_C_im, A_log_dt, A_Dskip) + _B_ref(xn, B_w1, B_w2)
```

```asm
; @launch kernel=k1_kernel grid=(512,1,1) block=(256,1,1) lds=53632
; @launch kernel=k2_kernel grid=(752,1,1) block=(256,1,1) lds=53632
; @launch kernel=k3_kernel grid=(512,1,1) block=(256,1,1) lds=77952
.amdgcn_target "amdgcn-amd-amdhsa--gfx950"
.text
.globl k1_kernel
.p2align 8
.type k1_kernel,@function
k1_kernel:
    s_cmp_ge_u32 s2, 512
    s_cbranch_scc1 k1_done
    v_lshrrev_b32 v1, 6, v0
    v_and_b32 v2, 63, v0
    s_load_dwordx2 s[6:7], s[0:1], 112
    v_readfirstlane_b32 s3, v1
    s_cmp_lt_u32 s2, 256
    s_cbranch_scc1 k1_kg

    s_load_dwordx2 s[4:5], s[0:1], 0
    s_setprio 0
    s_load_dwordx8 s[40:47], s[0:1], 8
    s_load_dwordx4 s[48:51], s[0:1], 40
    v_lshlrev_b32 v3, 4, v2
    s_movk_i32 s22, 4224
    v_mul_lo_u32 v5, v0, s22
    s_waitcnt lgkmcnt(0)

    s_add_u32 s16, s6, 0x200000
    s_addc_u32 s17, s7, 0
    s_and_b32 s17, s17, 0xffff
    s_mov_b32 s18, 0x210000
    s_mov_b32 s19, 0x00020000

    s_mov_b32 s8, s4
    s_and_b32 s9, s5, 0xffff
    s_mov_b32 s10, 0x200000
    s_mov_b32 s11, 0x00020000

    s_mov_b32 s12, s6
    s_and_b32 s13, s7, 0xffff
    s_mov_b32 s14, 0x200000
    s_mov_b32 s15, 0x00020000

    s_and_b32 s20, s2, 7
    s_lshl_b32 s20, s20, 5
    s_sub_u32 s21, s2, 256
    s_lshr_b32 s21, s21, 3
    s_add_u32 s20, s20, s21
    s_lshl_b32 s21, s20, 13
    s_lshl_b32 s22, s3, 11
    s_add_u32 s21, s21, s22
    buffer_load_dwordx4 v[10:13], v3, s[8:11], s21 offen
    buffer_load_dwordx4 v[14:17], v3, s[8:11], s21 offen offset:1024

    s_lshl_b32 s22, s2, 8
    v_lshl_add_u32 v66, v2, 2, s22

    s_mov_b32 s28, s40
    s_and_b32 s29, s41, 0xffff
    s_mov_b32 s30, 0x20000
    s_mov_b32 s31, 0x00020000

    buffer_load_dword v68, v66, s[28:31], 0 offen
    s_mov_b32 s28, s42
    s_and_b32 s29, s43, 0xffff
    s_mov_b32 s30, 0x20000
    s_mov_b32 s31, 0x00020000

    buffer_load_dword v68, v66, s[28:31], 0 offen
    s_mov_b32 s28, s44
    s_and_b32 s29, s45, 0xffff
    s_mov_b32 s30, 0x20000
    s_mov_b32 s31, 0x00020000

    buffer_load_dword v68, v66, s[28:31], 0 offen
    s_mov_b32 s28, s46
    s_and_b32 s29, s47, 0xffff
    s_mov_b32 s30, 0x20000
    s_mov_b32 s31, 0x00020000

    buffer_load_dword v68, v66, s[28:31], 0 offen
    s_mov_b32 s28, s48
    s_and_b32 s29, s49, 0xffff
    s_mov_b32 s30, 0x20000
    s_mov_b32 s31, 0x00020000

    buffer_load_dword v68, v66, s[28:31], 0 offen
    s_mov_b32 s28, s50
    s_and_b32 s29, s51, 0xffff
    s_mov_b32 s30, 0x20000
    s_mov_b32 s31, 0x00020000

    buffer_load_dword v68, v66, s[28:31], 0 offen
    s_mov_b32 s23, 0xffff0000
    s_mov_b32 s34, 0x3b000000
    s_mov_b32 s35, 0x3727c5ac
    s_mul_i32 s22, s3, 2176
    v_add_u32 v4, s22, v3
    v_bfe_u32 v6, v2, 2, 2
    v_mul_u32_u24 v6, 1088, v6
    v_lshrrev_b32 v7, 4, v0
    v_lshl_add_u32 v6, v7, 5, v6
    v_and_b32 v7, 3, v2
    v_lshl_add_u32 v6, v7, 3, v6
    s_lshl_b32 s24, s20, 4
    s_add_u32 s24, s24, 64
    s_add_u32 s25, s24, 0x108000
    v_and_b32 v8, 7, v0
    v_lshrrev_b32 v9, 3, v0
    v_mul_u32_u24 v7, 1088, v8
    v_lshl_add_u32 v7, v9, 4, v7
    v_lshlrev_b32 v9, 9, v9
    v_lshl_add_u32 v9, v8, 4, v9
    v_mov_b32 v8, v7
    s_lshr_b32 s21, s20, 2
    s_lshl_b32 s21, s21, 15
    s_and_b32 s22, s20, 3
    s_lshl_b32 s22, s22, 7
    s_add_u32 s21, s21, s22
    s_add_u32 s22, s21, 0x4000

    s_waitcnt vmcnt(7)
    v_lshlrev_b32 v20, 16, v10
    v_and_b32 v21, s23, v10
    v_lshlrev_b32 v22, 16, v11
    v_and_b32 v23, s23, v11
    v_lshlrev_b32 v24, 16, v12
    v_and_b32 v25, s23, v12
    v_lshlrev_b32 v26, 16, v13
    v_and_b32 v27, s23, v13
    v_add_f32 v40, v20, v21
    v_add_f32 v41, v22, v23
    v_add_f32 v42, v24, v25
    v_add_f32 v43, v26, v27
    v_add_f32 v40, v40, v41
    v_add_f32 v42, v42, v43
    v_add_f32 v36, v40, v42

    s_waitcnt vmcnt(6)
    v_lshlrev_b32 v28, 16, v14
    v_and_b32 v29, s23, v14
    v_lshlrev_b32 v30, 16, v15
    v_and_b32 v31, s23, v15
    v_lshlrev_b32 v32, 16, v16
    v_and_b32 v33, s23, v16
    v_lshlrev_b32 v34, 16, v17
    v_and_b32 v35, s23, v17
    v_add_f32 v44, v28, v29
    v_add_f32 v45, v30, v31
    v_add_f32 v46, v32, v33
    v_add_f32 v47, v34, v35
    v_add_f32 v44, v44, v45
    v_add_f32 v46, v46, v47
    v_add_f32 v37, v44, v46

    v_add_f32_dpp v36, v36, v36 row_shr:1 row_mask:0xf bank_mask:0xf bound_ctrl:0
    v_add_f32_dpp v37, v37, v37 row_shr:1 row_mask:0xf bank_mask:0xf bound_ctrl:0
    s_nop 0
    v_add_f32_dpp v36, v36, v36 row_shr:2 row_mask:0xf bank_mask:0xf bound_ctrl:0
    v_add_f32_dpp v37, v37, v37 row_shr:2 row_mask:0xf bank_mask:0xf bound_ctrl:0
    s_nop 0
    v_add_f32_dpp v36, v36, v36 row_shr:4 row_mask:0xf bank_mask:0xf bound_ctrl:0
    v_add_f32_dpp v37, v37, v37 row_shr:4 row_mask:0xf bank_mask:0xf bound_ctrl:0
    s_nop 0
    v_add_f32_dpp v36, v36, v36 row_shr:8 row_mask:0xf bank_mask:0xf bound_ctrl:0
    v_add_f32_dpp v37, v37, v37 row_shr:8 row_mask:0xf bank_mask:0xf bound_ctrl:0
    s_nop 0
    v_add_f32_dpp v36, v36, v36 row_bcast:15 row_mask:0xa bank_mask:0xf
    v_add_f32_dpp v37, v37, v37 row_bcast:15 row_mask:0xa bank_mask:0xf
    s_nop 0
    v_add_f32_dpp v36, v36, v36 row_bcast:31 row_mask:0xc bank_mask:0xf
    v_add_f32_dpp v37, v37, v37 row_bcast:31 row_mask:0xc bank_mask:0xf
    s_nop 1
    v_readlane_b32 s26, v36, 63
    v_readlane_b32 s27, v37, 63
    s_nop 1
    v_mov_b32 v38, s26
    v_mul_f32 v38, s34, v38
    v_mov_b32 v39, s27
    v_mul_f32 v39, s34, v39
    v_sub_f32 v40, v20, v38
    v_sub_f32 v41, v21, v38
    v_sub_f32 v42, v22, v38
    v_sub_f32 v43, v23, v38
    v_sub_f32 v44, v24, v38
    v_sub_f32 v45, v25, v38
    v_sub_f32 v46, v26, v38
    v_sub_f32 v47, v27, v38
    v_mul_f32 v36, v40, v40
    v_mul_f32 v48, v41, v41
    v_fmac_f32 v36, v42, v42
    v_fmac_f32 v48, v43, v43
    v_fmac_f32 v36, v44, v44
    v_fmac_f32 v48, v45, v45
    v_fmac_f32 v36, v46, v46
    v_fmac_f32 v48, v47, v47
    v_add_f32 v36, v36, v48
    v_sub_f32 v50, v28, v39
    v_sub_f32 v51, v29, v39
    v_sub_f32 v52, v30, v39
    v_sub_f32 v53, v31, v39
    v_sub_f32 v54, v32, v39
    v_sub_f32 v55, v33, v39
    v_sub_f32 v56, v34, v39
    v_sub_f32 v57, v35, v39
    v_mul_f32 v37, v50, v50
    v_mul_f32 v58, v51, v51
    v_fmac_f32 v37, v52, v52
    v_fmac_f32 v58, v53, v53
    v_fmac_f32 v37, v54, v54
    v_fmac_f32 v58, v55, v55
    v_fmac_f32 v37, v56, v56
    v_fmac_f32 v58, v57, v57
    v_add_f32 v37, v37, v58
    s_nop 1
    v_add_f32_dpp v36, v36, v36 row_shr:1 row_mask:0xf bank_mask:0xf bound_ctrl:0
    v_add_f32_dpp v37, v37, v37 row_shr:1 row_mask:0xf bank_mask:0xf bound_ctrl:0
    s_nop 0
    v_add_f32_dpp v36, v36, v36 row_shr:2 row_mask:0xf bank_mask:0xf bound_ctrl:0
    v_add_f32_dpp v37, v37, v37 row_shr:2 row_mask:0xf bank_mask:0xf bound_ctrl:0
    s_nop 0
    v_add_f32_dpp v36, v36, v36 row_shr:4 row_mask:0xf bank_mask:0xf bound_ctrl:0
    v_add_f32_dpp v37, v37, v37 row_shr:4 row_mask:0xf bank_mask:0xf bound_ctrl:0
    s_nop 0
    v_add_f32_dpp v36, v36, v36 row_shr:8 row_mask:0xf bank_mask:0xf bound_ctrl:0
    v_add_f32_dpp v37, v37, v37 row_shr:8 row_mask:0xf bank_mask:0xf bound_ctrl:0
    s_nop 0
    v_add_f32_dpp v36, v36, v36 row_bcast:15 row_mask:0xa bank_mask:0xf
    v_add_f32_dpp v37, v37, v37 row_bcast:15 row_mask:0xa bank_mask:0xf
    s_nop 0
    v_add_f32_dpp v36, v36, v36 row_bcast:31 row_mask:0xc bank_mask:0xf
    v_add_f32_dpp v37, v37, v37 row_bcast:31 row_mask:0xc bank_mask:0xf
    s_nop 1
    v_readlane_b32 s26, v36, 63
    v_readlane_b32 s27, v37, 63
    s_nop 1
    v_mov_b32 v40, s26
    v_mul_f32 v40, s34, v40
    v_cvt_pk_bf16_f32 v40, v40, v40
    v_and_b32 v40, s23, v40
    v_add_f32 v40, s35, v40
    v_cvt_pk_bf16_f32 v40, v40, v40
    v_and_b32 v40, s23, v40
    v_sqrt_f32 v41, v40
    v_cvt_pk_bf16_f32 v38, v38, v38
    v_rcp_f32 v42, v41
    v_and_b32 v38, s23, v38
    v_fma_f32 v43, -v41, v41, v40
    v_mul_f32 v42, 0.5, v42
    v_fma_f32 v41, v43, v42, v41
    v_cvt_pk_bf16_f32 v41, v41, v41
    v_and_b32 v41, s23, v41
    v_rcp_f32 v60, v41

    v_mov_b32 v44, s27
    v_mul_f32 v44, s34, v44
    v_cvt_pk_bf16_f32 v44, v44, v44
    v_and_b32 v44, s23, v44
    v_add_f32 v44, s35, v44
    v_cvt_pk_bf16_f32 v44, v44, v44
    v_and_b32 v44, s23, v44
    v_sqrt_f32 v45, v44
    v_cvt_pk_bf16_f32 v39, v39, v39
    v_rcp_f32 v46, v45
    v_and_b32 v39, s23, v39
    v_fma_f32 v47, -v45, v45, v44
    v_mul_f32 v46, 0.5, v46
    v_fma_f32 v45, v47, v46, v45
    v_cvt_pk_bf16_f32 v45, v45, v45
    v_and_b32 v45, s23, v45
    v_rcp_f32 v61, v45

    v_sub_f32 v20, v20, v38
    v_sub_f32 v21, v21, v38
    v_sub_f32 v22, v22, v38
    v_sub_f32 v23, v23, v38
    v_sub_f32 v24, v24, v38
    v_sub_f32 v25, v25, v38
    v_sub_f32 v26, v26, v38
    v_sub_f32 v27, v27, v38
    v_cvt_pk_bf16_f32 v10, v20, v21
    v_cvt_pk_bf16_f32 v11, v22, v23
    v_cvt_pk_bf16_f32 v12, v24, v25
    v_cvt_pk_bf16_f32 v13, v26, v27
    v_lshlrev_b32 v20, 16, v10
    v_and_b32 v21, s23, v10
    v_lshlrev_b32 v22, 16, v11
    v_and_b32 v23, s23, v11
    v_lshlrev_b32 v24, 16, v12
    v_and_b32 v25, s23, v12
    v_lshlrev_b32 v26, 16, v13
    v_and_b32 v27, s23, v13
    v_mul_f32 v20, v20, v60
    v_mul_f32 v21, v21, v60
    v_mul_f32 v22, v22, v60
    v_mul_f32 v23, v23, v60
    v_mul_f32 v24, v24, v60
    v_mul_f32 v25, v25, v60
    v_mul_f32 v26, v26, v60
    v_mul_f32 v27, v27, v60
    v_cvt_pk_bf16_f32 v10, v20, v21
    v_cvt_pk_bf16_f32 v11, v22, v23
    v_cvt_pk_bf16_f32 v12, v24, v25
    v_cvt_pk_bf16_f32 v13, v26, v27
    ds_write_b128 v4, v[10:13] offset:0
    v_sub_f32 v28, v28, v39
    v_sub_f32 v29, v29, v39
    v_sub_f32 v30, v30, v39
    v_sub_f32 v31, v31, v39
    v_sub_f32 v32, v32, v39
    v_sub_f32 v33, v33, v39
    v_sub_f32 v34, v34, v39
    v_sub_f32 v35, v35, v39
    v_cvt_pk_bf16_f32 v14, v28, v29
    v_cvt_pk_bf16_f32 v15, v30, v31
    v_cvt_pk_bf16_f32 v16, v32, v33
    v_cvt_pk_bf16_f32 v17, v34, v35
    v_lshlrev_b32 v28, 16, v14
    v_and_b32 v29, s23, v14
    v_lshlrev_b32 v30, 16, v15
    v_and_b32 v31, s23, v15
    v_lshlrev_b32 v32, 16, v16
    v_and_b32 v33, s23, v16
    v_lshlrev_b32 v34, 16, v17
    v_and_b32 v35, s23, v17
    v_mul_f32 v28, v28, v61
    v_mul_f32 v29, v29, v61
    v_mul_f32 v30, v30, v61
    v_mul_f32 v31, v31, v61
    v_mul_f32 v32, v32, v61
    v_mul_f32 v33, v33, v61
    v_mul_f32 v34, v34, v61
    v_mul_f32 v35, v35, v61
    v_cvt_pk_bf16_f32 v14, v28, v29
    v_cvt_pk_bf16_f32 v15, v30, v31
    v_cvt_pk_bf16_f32 v16, v32, v33
    v_cvt_pk_bf16_f32 v17, v34, v35
    ds_write_b128 v4, v[14:17] offset:1088
    s_waitcnt lgkmcnt(0)
    s_barrier

    ds_read_b64_tr_b16 v[20:21], v6
    ds_read_b64_tr_b16 v[22:23], v6 offset:4352
    ds_read_b64_tr_b16 v[24:25], v6 offset:512
    ds_read_b64_tr_b16 v[26:27], v6 offset:4864
    ds_read_b128 v[28:31], v8
    ds_read_b128 v[32:35], v8 offset:512
    s_waitcnt lgkmcnt(4)
    buffer_store_dwordx4 v[20:23], v5, s[16:19], s24 offen
    s_waitcnt lgkmcnt(2)
    buffer_store_dwordx4 v[24:27], v5, s[16:19], s25 offen
    s_waitcnt lgkmcnt(1)
    buffer_store_dwordx4 v[28:31], v9, s[12:15], s21 offen sc0 sc1
    s_waitcnt lgkmcnt(0)
    buffer_store_dwordx4 v[32:35], v9, s[12:15], s22 offen sc0 sc1

    s_branch k1_done
k1_kg:
    s_load_dwordx8 s[40:47], s[0:1], 8
    s_load_dwordx4 s[48:51], s[0:1], 40
    s_load_dwordx2 s[52:53], s[0:1], 56
    s_load_dwordx2 s[56:57], s[0:1], 80
    s_mov_b32 s20, s2
    s_lshl_b32 s27, s20, 8
    s_lshl_b32 s28, s3, 6
    s_add_u32 s27, s27, s28
    v_and_b32 v4, 31, v2
    v_lshrrev_b32 v6, 5, v2
    v_lshlrev_b32 v7, 1, v4
    v_add_u32 v7, s27, v7
    s_lshl_b32 s27, s20, 1
    v_mov_b32 v14, s27
    s_waitcnt lgkmcnt(0)
    global_load_ushort v80, v7, s[40:41]
    global_load_ushort v81, v7, s[42:43]
    global_load_ushort v82, v7, s[44:45]
    global_load_ushort v83, v7, s[46:47]
    global_load_ushort v84, v7, s[48:49]
    global_load_ushort v85, v7, s[50:51]
    global_load_ushort v86, v14, s[52:53]

    s_add_u32 s8, s6, 0x200000
    s_addc_u32 s9, s7, 0
    s_and_b32 s9, s9, 0xffff
    s_mov_b32 s10, 0x210000
    s_mov_b32 s11, 0x00020000

    s_add_u32 s12, s6, 0x620000
    s_addc_u32 s13, s7, 0
    s_and_b32 s13, s13, 0xffff
    s_mov_b32 s14, 0x400000
    s_mov_b32 s15, 0x00020000

    v_mov_b32 v30, 0
    v_mov_b32 v16, 0x3020100
    v_mov_b32 v17, 0x7060504
    v_mov_b32 v18, 0xd090c08
    v_mov_b32 v19, 0x160b150a
    v_mov_b32 v20, 0x1117100e
    v_mov_b32 v21, 0x1a19180f
    v_mov_b32 v22, 0x1c1b1412
    v_mov_b32 v23, 0x1f1e1d13
    ds_write_b128 v30, v[16:19] offset:26752
    ds_write_b128 v30, v[20:23] offset:26768
    v_mov_b32 v24, 0x4000000
    v_mov_b32 v25, 0x8080608
    v_mov_b32 v26, 0x8000600
    v_mov_b32 v27, 0x6040a00
    v_mov_b32 v28, 0x804
    ds_write_b128 v30, v[24:27] offset:26784
    ds_write_b32 v30, v28 offset:26800
    v_sub_u32 v3, 0xff, v0
    v_sub_u32 v14, 0x100, v0
    v_and_b32 v16, 31, v3
    v_and_b32 v17, 31, v14
    v_lshrrev_b32 v18, 5, v3
    v_lshrrev_b32 v19, 5, v14
    v_lshlrev_b32 v18, 1, v18
    v_lshlrev_b32 v19, 1, v19
    ds_read_u8 v16, v16 offset:26752
    ds_read_u16 v18, v18 offset:26784
    ds_read_u8 v17, v17 offset:26752
    ds_read_u16 v19, v19 offset:26784
    v_lshlrev_b32 v5, 4, v0
    v_and_b32 v15, 1, v3
    v_lshlrev_b32 v3, 5, v0
    v_cmp_eq_u32 vcc, 1, v15
    s_cmp_eq_u32 s3, 2
    s_waitcnt lgkmcnt(0)
    v_lshl_add_u32 v16, v16, 4, v18
    v_lshl_add_u32 v17, v17, 4, v19
    s_cbranch_scc1 k1_ad_w2
    s_cmp_eq_u32 s3, 3
    s_cbranch_scc1 k1_ad_w3

    v_mov_b32 v67, v16
    v_mov_b32 v66, v16
    v_mov_b32 v65, v16
    v_mov_b32 v64, v16
    v_cndmask_b32 v63, v16, v17, vcc
    v_mov_b32 v62, v17
    v_mov_b32 v61, v17
    v_mov_b32 v60, v17
    s_branch k1_ad_done
k1_ad_w2:
    v_add_u32 v18, 0x4, v16
    s_mov_b32 exec_hi, 0
    v_add_u32 v18, 0x4, v16
    s_mov_b32 exec_hi, -1

    v_mov_b32 v67, v16
    v_mov_b32 v66, v16
    v_mov_b32 v65, v16
    v_mov_b32 v64, v18
    v_mov_b32 v63, v18
    v_mov_b32 v62, v18
    v_mov_b32 v61, v17
    v_mov_b32 v60, v17
    s_branch k1_ad_done
k1_ad_w3:
    v_add_u32 v67, 0x0, v16
    v_add_u32 v66, 0x4, v16
    v_add_u32 v65, 0x8, v16
    v_add_u32 v64, 0xc, v16
    v_add_u32 v63, 0x200, v16
    v_add_u32 v62, 0x204, v16
    v_add_u32 v61, 0x208, v16
    v_add_u32 v60, 0x20c, v16
    s_mov_b32 exec_hi, 0
    v_add_u32 v67, 0x0, v16
    v_add_u32 v66, 0x0, v16
    v_add_u32 v65, 0x4, v16
    v_add_u32 v64, 0x8, v16
    v_add_u32 v63, 0x8, v16
    v_add_u32 v62, 0x8, v16
    v_add_u32 v61, 0xc, v16
    v_mov_b32 v60, v17
    s_mov_b32 exec_hi, -1
k1_ad_done:
    s_cmp_lg_u32 s2, 0
    s_cbranch_scc1 k1_kg_notab

    s_add_u32 s28, s6, 0x420000
    s_addc_u32 s29, s7, 0
    s_and_b32 s29, s29, 0xffff
    s_mov_b32 s30, 0x10000
    s_mov_b32 s31, 0x00020000

    v_mov_b32 v16, 0
    v_mov_b32 v17, 0
    v_mov_b32 v18, 0
    v_mov_b32 v19, 0
    s_movk_i32 s24, 0x4000
    buffer_store_dwordx4 v[60:63], v3, s[28:31], 0 offen
    buffer_store_dwordx4 v[64:67], v3, s[28:31], 0 offen offset:16
    buffer_store_dwordx4 v[16:19], v5, s[28:31], s24 offen
    s_mov_b32 s24, 0x8000
    buffer_store_dwordx4 v[16:19], v5, s[28:31], s24 offen
    s_mov_b32 s24, 0x9000
    buffer_store_dwordx4 v[16:19], v5, s[28:31], s24 offen
    s_mov_b32 s24, 0xa000
    buffer_store_dwordx4 v[16:19], v5, s[28:31], s24 offen
    s_mov_b32 s24, 0xb000
    buffer_store_dwordx4 v[16:19], v5, s[28:31], s24 offen

k1_kg_notab:
    s_mov_b32 s54, 0
    s_mov_b32 s55, -1
    s_mul_i32 s32, s3, 6656
    v_lshlrev_b32 v12, 12, v6
    v_add_u32 v12, s32, v12
    v_and_b32 v13, 3, v4
    v_lshl_add_u32 v12, v13, 2, v12
    v_lshrrev_b32 v13, 2, v4
    v_lshl_add_u32 v12, v13, 4, v12

    v_xor_b32 v40, 0, v12
    v_xor_b32 v41, 128, v12
    v_xor_b32 v42, 16, v12
    v_xor_b32 v43, 144, v12
    v_xor_b32 v44, 32, v12
    v_xor_b32 v45, 160, v12
    v_xor_b32 v46, 48, v12
    v_xor_b32 v47, 176, v12
    v_xor_b32 v48, 64, v12
    v_xor_b32 v49, 192, v12
    v_xor_b32 v50, 80, v12
    v_xor_b32 v51, 208, v12
    v_xor_b32 v52, 96, v12
    v_xor_b32 v53, 224, v12
    v_xor_b32 v54, 112, v12
    v_xor_b32 v55, 240, v12
    v_mov_b32 v13, s32
    v_cndmask_b32 v13, v13, 0, s[54:55]
    v_sub_u32 v56, v12, v13
    v_mov_b32 v14, 0x41000000
    v_cndmask_b32 v12, v14, 1.0, s[54:55]
    v_cndmask_b32 v13, v14, -1.0, s[54:55]
    v_mov_b32 v14, 0x42800000
    v_mov_b32 v15, 0x43800000
    v_cndmask_b32 v57, v14, v15, s[54:55]
    v_cndmask_b32 v58, v14, -v15, s[54:55]
    s_mov_b32 s33, 0x3fb8aa3b
    s_mov_b32 s34, 0x3e22f983
    s_mov_b32 s35, 0xffff0000
    s_mov_b32 s36, 0x0000bf80
    s_mov_b32 s37, 0x80000000
    s_waitcnt vmcnt(0)

    s_mov_b32 s56, s56
    s_and_b32 s57, s57, 0xffff
    s_mov_b32 s58, 0x158000
    s_mov_b32 s59, 0x00020000

    s_lshl_b32 s27, s2, 6
    v_lshl_add_u32 v9, v0, 14, s27
    buffer_load_dword v8, v9, s[56:59], 0 offen

    v_lshlrev_b32 v86, 16, v86
    v_mul_f32 v86, s33, v86
    v_exp_f32 v86, v86
    v_lshlrev_b32 v80, 16, v80
    v_lshlrev_b32 v81, 16, v81
    v_lshlrev_b32 v82, 16, v82
    v_lshlrev_b32 v83, 16, v83
    v_lshlrev_b32 v84, 16, v84
    v_lshlrev_b32 v85, 16, v85
    v_cvt_pk_bf16_f32 v86, v86, v86
    v_and_b32 v86, s35, v86
    v_mul_f32 v80, v86, v80
    v_mul_f32 v81, v86, v81
    v_mul_f32 v82, v86, v82
    v_mul_f32 v83, v86, v83
    v_mul_f32 v88, s33, v80
    v_mul_f32 v89, s34, v81
    v_mul_f32 v68, v88, v12
    v_mul_f32 v69, v89, v13
    v_mul_f32 v70, v88, v57
    v_mul_f32 v71, v89, v58
    v_exp_f32 v68, v68
    v_fract_f32 v69, v69
    v_exp_f32 v70, v70
    v_fract_f32 v71, v71
    v_cos_f32 v92, v69
    v_sin_f32 v93, v69
    v_cos_f32 v106, v71
    v_sin_f32 v107, v71
    v_mul_f32 v90, v84, v82
    v_fma_f32 v90, -v85, v83, v90
    v_mul_f32 v91, v84, v83
    v_fma_f32 v91, v85, v82, v91
    v_mul_f32 v92, v68, v92
    v_mul_f32 v93, v68, v93
    v_mul_f32 v106, v70, v106
    v_mul_f32 v107, v70, v107
    v_cndmask_b32 v114, 1.0, v90, s[54:55]
    v_cndmask_b32 v115, 0, -v91, s[54:55]

    v_pk_mul_f32 v[94:95], v[92:93], v[92:93] op_sel:[0,0] op_sel_hi:[0,1]
    v_pk_mul_f32 v[108:109], v[106:107], v[106:107] op_sel:[0,0] op_sel_hi:[0,1]
    v_pk_fma_f32 v[94:95], v[92:93], v[92:93], v[94:95] op_sel:[1,1,0] op_sel_hi:[1,0,1] neg_lo:[1,0,0]
    v_pk_fma_f32 v[108:109], v[106:107], v[106:107], v[108:109] op_sel:[1,1,0] op_sel_hi:[1,0,1] neg_lo:[1,0,0]

    v_pk_mul_f32 v[96:97], v[94:95], v[92:93] op_sel:[0,0] op_sel_hi:[0,1]
    v_pk_mul_f32 v[110:111], v[108:109], v[106:107] op_sel:[0,0] op_sel_hi:[0,1]
    v_pk_fma_f32 v[96:97], v[94:95], v[92:93], v[96:97] op_sel:[1,1,0] op_sel_hi:[1,0,1] neg_lo:[1,0,0]
    v_pk_fma_f32 v[110:111], v[108:109], v[106:107], v[110:111] op_sel:[1,1,0] op_sel_hi:[1,0,1] neg_lo:[1,0,0]

    v_pk_mul_f32 v[98:99], v[94:95], v[94:95] op_sel:[0,0] op_sel_hi:[0,1]
    v_pk_mul_f32 v[116:117], v[114:115], v[106:107] op_sel:[0,0] op_sel_hi:[0,1]
    v_pk_fma_f32 v[98:99], v[94:95], v[94:95], v[98:99] op_sel:[1,1,0] op_sel_hi:[1,0,1] neg_lo:[1,0,0]
    v_pk_fma_f32 v[116:117], v[114:115], v[106:107], v[116:117] op_sel:[1,1,0] op_sel_hi:[1,0,1] neg_lo:[1,0,0]

    v_pk_mul_f32 v[102:103], v[96:97], v[96:97] op_sel:[0,0] op_sel_hi:[0,1]
    v_pk_mul_f32 v[112:113], v[110:111], v[110:111] op_sel:[0,0] op_sel_hi:[0,1]
    v_pk_fma_f32 v[102:103], v[96:97], v[96:97], v[102:103] op_sel:[1,1,0] op_sel_hi:[1,0,1] neg_lo:[1,0,0]
    v_pk_fma_f32 v[112:113], v[110:111], v[110:111], v[112:113] op_sel:[1,1,0] op_sel_hi:[1,0,1] neg_lo:[1,0,0]

    v_pk_mul_f32 v[100:101], v[98:99], v[92:93] op_sel:[0,0] op_sel_hi:[0,1]
    v_pk_mul_f32 v[118:119], v[114:115], v[108:109] op_sel:[0,0] op_sel_hi:[0,1]
    v_pk_fma_f32 v[100:101], v[98:99], v[92:93], v[100:101] op_sel:[1,1,0] op_sel_hi:[1,0,1] neg_lo:[1,0,0]
    v_pk_fma_f32 v[118:119], v[114:115], v[108:109], v[118:119] op_sel:[1,1,0] op_sel_hi:[1,0,1] neg_lo:[1,0,0]

    v_pk_mul_f32 v[104:105], v[98:99], v[96:97] op_sel:[0,0] op_sel_hi:[0,1]
    v_pk_mul_f32 v[120:121], v[114:115], v[110:111] op_sel:[0,0] op_sel_hi:[0,1]
    v_pk_fma_f32 v[104:105], v[98:99], v[96:97], v[104:105] op_sel:[1,1,0] op_sel_hi:[1,0,1] neg_lo:[1,0,0]
    v_pk_fma_f32 v[120:121], v[114:115], v[110:111], v[120:121] op_sel:[1,1,0] op_sel_hi:[1,0,1] neg_lo:[1,0,0]

    v_cndmask_b32 v122, v92, v110, s[54:55]
    v_cndmask_b32 v123, v93, v111, s[54:55]
    v_cndmask_b32 v124, v96, v112, s[54:55]
    v_cndmask_b32 v125, v97, v113, s[54:55]
    v_xor_b32 v84, s37, v115
    v_xor_b32 v85, s37, v117
    v_xor_b32 v86, s37, v119
    v_xor_b32 v87, s37, v121

    v_pk_mul_f32 v[72:73], v[114:115], v[92:93] op_sel:[0,0] op_sel_hi:[0,1]
    v_pk_fma_f32 v[72:73], v[114:115], v[92:93], v[72:73] op_sel:[1,1,0] op_sel_hi:[1,0,1] neg_lo:[1,0,0]
    v_cvt_pk_bf16_f32 v70, v114, v115
    v_cvt_pk_bf16_f32 v74, v72, v73
    v_lshlrev_b32 v88, 16, v70
    v_and_b32 v89, s35, v70
    v_lshlrev_b32 v90, 16, v74
    v_and_b32 v91, s35, v74
    v_pk_add_f32 v[68:69], v[114:115], v[88:89] neg_lo:[0,1] neg_hi:[0,1]
    v_pk_add_f32 v[72:73], v[72:73], v[90:91] neg_lo:[0,1] neg_hi:[0,1]
    v_pk_mul_f32 v[76:77], v[114:115], v[94:95] op_sel:[0,0] op_sel_hi:[0,1]
    v_pk_mul_f32 v[80:81], v[114:115], v[96:97] op_sel:[0,0] op_sel_hi:[0,1]
    v_pk_fma_f32 v[76:77], v[114:115], v[94:95], v[76:77] op_sel:[1,1,0] op_sel_hi:[1,0,1] neg_lo:[1,0,0]
    v_pk_fma_f32 v[80:81], v[114:115], v[96:97], v[80:81] op_sel:[1,1,0] op_sel_hi:[1,0,1] neg_lo:[1,0,0]
    v_cvt_pk_bf16_f32 v71, v68, v69
    v_cvt_pk_bf16_f32 v75, v72, v73
    ds_write2st64_b32 v56, v70, v71 offset0:0 offset1:105
    ds_write2st64_b32 v41, v74, v75 offset0:0 offset1:105
    v_cvt_pk_bf16_f32 v78, v76, v77
    v_cvt_pk_bf16_f32 v82, v80, v81
    v_lshlrev_b32 v88, 16, v78
    v_and_b32 v89, s35, v78
    v_lshlrev_b32 v90, 16, v82
    v_and_b32 v91, s35, v82
    v_pk_add_f32 v[76:77], v[76:77], v[88:89] neg_lo:[0,1] neg_hi:[0,1]
    v_pk_add_f32 v[80:81], v[80:81], v[90:91] neg_lo:[0,1] neg_hi:[0,1]
    v_pk_mul_f32 v[68:69], v[114:115], v[98:99] op_sel:[0,0] op_sel_hi:[0,1]
    v_pk_mul_f32 v[72:73], v[114:115], v[100:101] op_sel:[0,0] op_sel_hi:[0,1]
    v_pk_fma_f32 v[68:69], v[114:115], v[98:99], v[68:69] op_sel:[1,1,0] op_sel_hi:[1,0,1] neg_lo:[1,0,0]
    v_pk_fma_f32 v[72:73], v[114:115], v[100:101], v[72:73] op_sel:[1,1,0] op_sel_hi:[1,0,1] neg_lo:[1,0,0]
    v_cvt_pk_bf16_f32 v79, v76, v77
    v_cvt_pk_bf16_f32 v83, v80, v81
    ds_write2st64_b32 v42, v78, v79 offset0:1 offset1:106
    ds_write2st64_b32 v43, v82, v83 offset0:1 offset1:106
    v_cvt_pk_bf16_f32 v70, v68, v69
    v_cvt_pk_bf16_f32 v74, v72, v73
    v_lshlrev_b32 v88, 16, v70
    v_and_b32 v89, s35, v70
    v_lshlrev_b32 v90, 16, v74
    v_and_b32 v91, s35, v74
    v_pk_add_f32 v[68:69], v[68:69], v[88:89] neg_lo:[0,1] neg_hi:[0,1]
    v_pk_add_f32 v[72:73], v[72:73], v[90:91] neg_lo:[0,1] neg_hi:[0,1]
    v_pk_mul_f32 v[76:77], v[114:115], v[102:103] op_sel:[0,0] op_sel_hi:[0,1]
    v_pk_mul_f32 v[80:81], v[114:115], v[104:105] op_sel:[0,0] op_sel_hi:[0,1]
    v_pk_fma_f32 v[76:77], v[114:115], v[102:103], v[76:77] op_sel:[1,1,0] op_sel_hi:[1,0,1] neg_lo:[1,0,0]
    v_pk_fma_f32 v[80:81], v[114:115], v[104:105], v[80:81] op_sel:[1,1,0] op_sel_hi:[1,0,1] neg_lo:[1,0,0]
    v_cvt_pk_bf16_f32 v71, v68, v69
    v_cvt_pk_bf16_f32 v75, v72, v73
    ds_write2st64_b32 v44, v70, v71 offset0:2 offset1:107
    ds_write2st64_b32 v45, v74, v75 offset0:2 offset1:107
    v_cvt_pk_bf16_f32 v78, v76, v77
    v_cvt_pk_bf16_f32 v82, v80, v81
    v_lshlrev_b32 v88, 16, v78
    v_and_b32 v89, s35, v78
    v_lshlrev_b32 v90, 16, v82
    v_and_b32 v91, s35, v82
    v_pk_add_f32 v[76:77], v[76:77], v[88:89] neg_lo:[0,1] neg_hi:[0,1]
    v_pk_add_f32 v[80:81], v[80:81], v[90:91] neg_lo:[0,1] neg_hi:[0,1]
    v_pk_mul_f32 v[72:73], v[116:117], v[94:95] op_sel:[0,0] op_sel_hi:[0,1]
    v_pk_fma_f32 v[72:73], v[116:117], v[94:95], v[72:73] op_sel:[1,1,0] op_sel_hi:[1,0,1] neg_lo:[1,0,0]
    v_cvt_pk_bf16_f32 v79, v76, v77
    v_cvt_pk_bf16_f32 v83, v80, v81
    ds_write2st64_b32 v46, v78, v79 offset0:3 offset1:108
    ds_write2st64_b32 v47, v82, v83 offset0:3 offset1:108
    v_cvt_pk_bf16_f32 v70, v116, v117
    v_cvt_pk_bf16_f32 v74, v72, v73
    v_lshlrev_b32 v88, 16, v70
    v_and_b32 v89, s35, v70
    v_lshlrev_b32 v90, 16, v74
    v_and_b32 v91, s35, v74
    v_pk_add_f32 v[68:69], v[116:117], v[88:89] neg_lo:[0,1] neg_hi:[0,1]
    v_pk_add_f32 v[72:73], v[72:73], v[90:91] neg_lo:[0,1] neg_hi:[0,1]
    v_pk_mul_f32 v[76:77], v[116:117], v[98:99] op_sel:[0,0] op_sel_hi:[0,1]
    v_pk_mul_f32 v[80:81], v[116:117], v[102:103] op_sel:[0,0] op_sel_hi:[0,1]
    v_pk_fma_f32 v[76:77], v[116:117], v[98:99], v[76:77] op_sel:[1,1,0] op_sel_hi:[1,0,1] neg_lo:[1,0,0]
    v_pk_fma_f32 v[80:81], v[116:117], v[102:103], v[80:81] op_sel:[1,1,0] op_sel_hi:[1,0,1] neg_lo:[1,0,0]
    v_cvt_pk_bf16_f32 v71, v68, v69
    v_cvt_pk_bf16_f32 v75, v72, v73
    ds_write2st64_b32 v48, v70, v71 offset0:4 offset1:109
    ds_write2st64_b32 v49, v74, v75 offset0:4 offset1:109
    v_cvt_pk_bf16_f32 v78, v76, v77
    v_cvt_pk_bf16_f32 v82, v80, v81
    v_lshlrev_b32 v88, 16, v78
    v_and_b32 v89, s35, v78
    v_lshlrev_b32 v90, 16, v82
    v_and_b32 v91, s35, v82
    v_pk_add_f32 v[76:77], v[76:77], v[88:89] neg_lo:[0,1] neg_hi:[0,1]
    v_pk_add_f32 v[80:81], v[80:81], v[90:91] neg_lo:[0,1] neg_hi:[0,1]
    v_pk_mul_f32 v[68:69], v[116:117], v[122:123] op_sel:[0,0] op_sel_hi:[0,1]
    v_pk_mul_f32 v[72:73], v[116:117], v[124:125] op_sel:[0,0] op_sel_hi:[0,1]
    v_pk_fma_f32 v[68:69], v[116:117], v[122:123], v[68:69] op_sel:[1,1,0] op_sel_hi:[1,0,1] neg_lo:[1,0,0]
    v_pk_fma_f32 v[72:73], v[116:117], v[124:125], v[72:73] op_sel:[1,1,0] op_sel_hi:[1,0,1] neg_lo:[1,0,0]
    v_cvt_pk_bf16_f32 v79, v76, v77
    v_cvt_pk_bf16_f32 v83, v80, v81
    ds_write2st64_b32 v50, v78, v79 offset0:5 offset1:110
    ds_write2st64_b32 v51, v82, v83 offset0:5 offset1:110
    v_cvt_pk_bf16_f32 v70, v68, v69
    v_cvt_pk_bf16_f32 v74, v72, v73
    v_lshlrev_b32 v88, 16, v70
    v_and_b32 v89, s35, v70
    v_lshlrev_b32 v90, 16, v74
    v_and_b32 v91, s35, v74
    v_pk_add_f32 v[68:69], v[68:69], v[88:89] neg_lo:[0,1] neg_hi:[0,1]
    v_pk_add_f32 v[72:73], v[72:73], v[90:91] neg_lo:[0,1] neg_hi:[0,1]
    v_pk_mul_f32 v[80:81], v[118:119], v[98:99] op_sel:[0,0] op_sel_hi:[0,1]
    v_pk_fma_f32 v[80:81], v[118:119], v[98:99], v[80:81] op_sel:[1,1,0] op_sel_hi:[1,0,1] neg_lo:[1,0,0]
    v_cvt_pk_bf16_f32 v71, v68, v69
    v_cvt_pk_bf16_f32 v75, v72, v73
    ds_write2st64_b32 v52, v70, v71 offset0:6 offset1:111
    ds_write2st64_b32 v53, v74, v75 offset0:6 offset1:111
    v_cvt_pk_bf16_f32 v78, v118, v119
    v_cvt_pk_bf16_f32 v82, v80, v81
    v_lshlrev_b32 v88, 16, v78
    v_and_b32 v89, s35, v78
    v_lshlrev_b32 v90, 16, v82
    v_and_b32 v91, s35, v82
    v_pk_add_f32 v[76:77], v[118:119], v[88:89] neg_lo:[0,1] neg_hi:[0,1]
    v_pk_add_f32 v[80:81], v[80:81], v[90:91] neg_lo:[0,1] neg_hi:[0,1]
    v_pk_mul_f32 v[68:69], v[118:119], v[122:123] op_sel:[0,0] op_sel_hi:[0,1]
    v_pk_mul_f32 v[72:73], v[118:119], v[124:125] op_sel:[0,0] op_sel_hi:[0,1]
    v_pk_fma_f32 v[68:69], v[118:119], v[122:123], v[68:69] op_sel:[1,1,0] op_sel_hi:[1,0,1] neg_lo:[1,0,0]
    v_pk_fma_f32 v[72:73], v[118:119], v[124:125], v[72:73] op_sel:[1,1,0] op_sel_hi:[1,0,1] neg_lo:[1,0,0]
    v_cvt_pk_bf16_f32 v79, v76, v77
    v_cvt_pk_bf16_f32 v83, v80, v81
    ds_write2st64_b32 v54, v78, v79 offset0:7 offset1:112
    ds_write2st64_b32 v55, v82, v83 offset0:7 offset1:112
    v_cvt_pk_bf16_f32 v70, v68, v69
    v_cvt_pk_bf16_f32 v74, v72, v73
    v_lshlrev_b32 v88, 16, v70
    v_and_b32 v89, s35, v70
    v_lshlrev_b32 v90, 16, v74
    v_and_b32 v91, s35, v74
    v_pk_add_f32 v[68:69], v[68:69], v[88:89] neg_lo:[0,1] neg_hi:[0,1]
    v_pk_add_f32 v[72:73], v[72:73], v[90:91] neg_lo:[0,1] neg_hi:[0,1]
    v_pk_mul_f32 v[80:81], v[120:121], v[98:99] op_sel:[0,0] op_sel_hi:[0,1]
    v_pk_fma_f32 v[80:81], v[120:121], v[98:99], v[80:81] op_sel:[1,1,0] op_sel_hi:[1,0,1] neg_lo:[1,0,0]
    v_cvt_pk_bf16_f32 v71, v68, v69
    v_cvt_pk_bf16_f32 v75, v72, v73
    ds_write2st64_b32 v40, v70, v71 offset0:8 offset1:113
    ds_write2st64_b32 v41, v74, v75 offset0:8 offset1:113
    v_cvt_pk_bf16_f32 v78, v120, v121
    v_cvt_pk_bf16_f32 v82, v80, v81
    v_lshlrev_b32 v88, 16, v78
    v_and_b32 v89, s35, v78
    v_lshlrev_b32 v90, 16, v82
    v_and_b32 v91, s35, v82
    v_pk_add_f32 v[76:77], v[120:121], v[88:89] neg_lo:[0,1] neg_hi:[0,1]
    v_pk_add_f32 v[80:81], v[80:81], v[90:91] neg_lo:[0,1] neg_hi:[0,1]
    v_pk_mul_f32 v[68:69], v[120:121], v[122:123] op_sel:[0,0] op_sel_hi:[0,1]
    v_pk_mul_f32 v[72:73], v[116:117], v[100:101] op_sel:[0,0] op_sel_hi:[0,1]
    v_pk_fma_f32 v[68:69], v[120:121], v[122:123], v[68:69] op_sel:[1,1,0] op_sel_hi:[1,0,1] neg_lo:[1,0,0]
    v_pk_fma_f32 v[72:73], v[116:117], v[100:101], v[72:73] op_sel:[1,1,0] op_sel_hi:[1,0,1] neg_lo:[1,0,0]
    v_cvt_pk_bf16_f32 v79, v76, v77
    v_cvt_pk_bf16_f32 v83, v80, v81
    ds_write2st64_b32 v42, v78, v79 offset0:9 offset1:114
    ds_write2st64_b32 v43, v82, v83 offset0:9 offset1:114
    v_cvt_pk_bf16_f32 v70, v68, v69
    v_cvt_pk_bf16_f32 v74, v72, v73
    v_lshlrev_b32 v88, 16, v70
    v_and_b32 v89, s35, v70
    v_lshlrev_b32 v90, 16, v74
    v_and_b32 v91, s35, v74
    v_pk_add_f32 v[68:69], v[68:69], v[88:89] neg_lo:[0,1] neg_hi:[0,1]
    v_pk_add_f32 v[72:73], v[72:73], v[90:91] neg_lo:[0,1] neg_hi:[0,1]
    v_pk_mul_f32 v[76:77], v[116:117], v[104:105] op_sel:[0,0] op_sel_hi:[0,1]
    v_pk_mul_f32 v[80:81], v[118:119], v[94:95] op_sel:[0,0] op_sel_hi:[0,1]
    v_pk_fma_f32 v[76:77], v[116:117], v[104:105], v[76:77] op_sel:[1,1,0] op_sel_hi:[1,0,1] neg_lo:[1,0,0]
    v_pk_fma_f32 v[80:81], v[118:119], v[94:95], v[80:81] op_sel:[1,1,0] op_sel_hi:[1,0,1] neg_lo:[1,0,0]
    v_cvt_pk_bf16_f32 v71, v68, v69
    v_cvt_pk_bf16_f32 v75, v72, v73
    ds_write2st64_b32 v44, v70, v71 offset0:10 offset1:115
    s_mov_b32 exec_hi, 0
    ds_write2st64_b32 v45, v74, v75 offset0:10 offset1:115
    v_cvt_pk_bf16_f32 v78, v76, v77
    v_cvt_pk_bf16_f32 v82, v80, v81
    v_lshlrev_b32 v88, 16, v78
    v_and_b32 v89, s35, v78
    v_lshlrev_b32 v90, 16, v82
    v_and_b32 v91, s35, v82
    v_pk_add_f32 v[76:77], v[76:77], v[88:89] neg_lo:[0,1] neg_hi:[0,1]
    v_pk_add_f32 v[80:81], v[80:81], v[90:91] neg_lo:[0,1] neg_hi:[0,1]
    v_pk_mul_f32 v[68:69], v[118:119], v[100:101] op_sel:[0,0] op_sel_hi:[0,1]
    v_pk_mul_f32 v[72:73], v[118:119], v[102:103] op_sel:[0,0] op_sel_hi:[0,1]
    v_pk_fma_f32 v[68:69], v[118:119], v[100:101], v[68:69] op_sel:[1,1,0] op_sel_hi:[1,0,1] neg_lo:[1,0,0]
    v_pk_fma_f32 v[72:73], v[118:119], v[102:103], v[72:73] op_sel:[1,1,0] op_sel_hi:[1,0,1] neg_lo:[1,0,0]
    v_cvt_pk_bf16_f32 v79, v76, v77
    v_cvt_pk_bf16_f32 v83, v80, v81
    ds_write2st64_b32 v46, v78, v79 offset0:11 offset1:116
    ds_write2st64_b32 v47, v82, v83 offset0:11 offset1:116
    v_cvt_pk_bf16_f32 v70, v68, v69
    v_cvt_pk_bf16_f32 v74, v72, v73
    v_lshlrev_b32 v88, 16, v70
    v_and_b32 v89, s35, v70
    v_lshlrev_b32 v90, 16, v74
    v_and_b32 v91, s35, v74
    v_pk_add_f32 v[68:69], v[68:69], v[88:89] neg_lo:[0,1] neg_hi:[0,1]
    v_pk_add_f32 v[72:73], v[72:73], v[90:91] neg_lo:[0,1] neg_hi:[0,1]
    v_pk_mul_f32 v[76:77], v[118:119], v[104:105] op_sel:[0,0] op_sel_hi:[0,1]
    v_pk_mul_f32 v[80:81], v[120:121], v[94:95] op_sel:[0,0] op_sel_hi:[0,1]
    v_pk_fma_f32 v[76:77], v[118:119], v[104:105], v[76:77] op_sel:[1,1,0] op_sel_hi:[1,0,1] neg_lo:[1,0,0]
    v_pk_fma_f32 v[80:81], v[120:121], v[94:95], v[80:81] op_sel:[1,1,0] op_sel_hi:[1,0,1] neg_lo:[1,0,0]
    v_cvt_pk_bf16_f32 v71, v68, v69
    v_cvt_pk_bf16_f32 v75, v72, v73
    ds_write2st64_b32 v48, v70, v71 offset0:12 offset1:117
    ds_write2st64_b32 v49, v74, v75 offset0:12 offset1:117
    v_cvt_pk_bf16_f32 v78, v76, v77
    v_cvt_pk_bf16_f32 v82, v80, v81
    v_lshlrev_b32 v88, 16, v78
    v_and_b32 v89, s35, v78
    v_lshlrev_b32 v90, 16, v82
    v_and_b32 v91, s35, v82
    v_pk_add_f32 v[76:77], v[76:77], v[88:89] neg_lo:[0,1] neg_hi:[0,1]
    v_pk_add_f32 v[80:81], v[80:81], v[90:91] neg_lo:[0,1] neg_hi:[0,1]
    v_pk_mul_f32 v[68:69], v[120:121], v[124:125] op_sel:[0,0] op_sel_hi:[0,1]
    v_pk_mul_f32 v[72:73], v[120:121], v[100:101] op_sel:[0,0] op_sel_hi:[0,1]
    v_pk_fma_f32 v[68:69], v[120:121], v[124:125], v[68:69] op_sel:[1,1,0] op_sel_hi:[1,0,1] neg_lo:[1,0,0]
    v_pk_fma_f32 v[72:73], v[120:121], v[100:101], v[72:73] op_sel:[1,1,0] op_sel_hi:[1,0,1] neg_lo:[1,0,0]
    v_cvt_pk_bf16_f32 v79, v76, v77
    v_cvt_pk_bf16_f32 v83, v80, v81
    ds_write2st64_b32 v50, v78, v79 offset0:13 offset1:118
    ds_write2st64_b32 v51, v82, v83 offset0:13 offset1:118
    v_cvt_pk_bf16_f32 v70, v68, v69
    v_cvt_pk_bf16_f32 v74, v72, v73
    v_lshlrev_b32 v88, 16, v70
    v_and_b32 v89, s35, v70
    v_lshlrev_b32 v90, 16, v74
    v_and_b32 v91, s35, v74
    v_pk_add_f32 v[68:69], v[68:69], v[88:89] neg_lo:[0,1] neg_hi:[0,1]
    v_pk_add_f32 v[72:73], v[72:73], v[90:91] neg_lo:[0,1] neg_hi:[0,1]
    v_pk_mul_f32 v[76:77], v[120:121], v[102:103] op_sel:[0,0] op_sel_hi:[0,1]
    v_pk_mul_f32 v[80:81], v[120:121], v[104:105] op_sel:[0,0] op_sel_hi:[0,1]
    v_pk_fma_f32 v[76:77], v[120:121], v[102:103], v[76:77] op_sel:[1,1,0] op_sel_hi:[1,0,1] neg_lo:[1,0,0]
    v_pk_fma_f32 v[80:81], v[120:121], v[104:105], v[80:81] op_sel:[1,1,0] op_sel_hi:[1,0,1] neg_lo:[1,0,0]
    v_cvt_pk_bf16_f32 v71, v68, v69
    v_cvt_pk_bf16_f32 v75, v72, v73
    ds_write2st64_b32 v52, v70, v71 offset0:14 offset1:119
    ds_write2st64_b32 v53, v74, v75 offset0:14 offset1:119
    v_cvt_pk_bf16_f32 v78, v76, v77
    v_cvt_pk_bf16_f32 v82, v80, v81
    v_lshlrev_b32 v88, 16, v78
    v_and_b32 v89, s35, v78
    v_lshlrev_b32 v90, 16, v82
    v_and_b32 v91, s35, v82
    v_pk_add_f32 v[76:77], v[76:77], v[88:89] neg_lo:[0,1] neg_hi:[0,1]
    v_pk_add_f32 v[80:81], v[80:81], v[90:91] neg_lo:[0,1] neg_hi:[0,1]
    v_cvt_pk_bf16_f32 v79, v76, v77
    v_cvt_pk_bf16_f32 v83, v80, v81
    ds_write2st64_b32 v54, v78, v79 offset0:15 offset1:120
    ds_write2st64_b32 v55, v82, v83 offset0:15 offset1:120
    s_mov_b64 exec, -1
    v_min_u32 v12, 20, v4
    v_bfe_u32 v13, v12, 1, 3
    v_xor_b32 v13, v13, v6
    v_lshlrev_b32 v13, 4, v13
    v_lshl_add_u32 v12, v12, 7, v13
    s_add_u32 s33, s32, 4096
    v_add_u32 v44, s33, v12
    v_bfe_u32 v13, v4, 1, 3
    v_xor_b32 v13, v13, v6
    v_lshlrev_b32 v13, 4, v13
    v_lshl_add_u32 v12, v4, 7, v13
    v_mov_b32 v14, s32
    v_cmp_eq_u32 vcc, 0, v4
    v_xor_b32 v45, 32, v44
    v_cndmask_b32 v14, v14, 0, vcc
    v_add_u32 v48, v14, v12
    v_xor_b32 v46, 64, v44
    v_xor_b32 v47, 96, v44
    v_xor_b32 v49, 32, v48
    v_xor_b32 v50, 64, v48
    v_xor_b32 v51, 96, v48
    s_waitcnt lgkmcnt(0)

    ds_read_b128 v[68:71], v44
    ds_read_b128 v[72:75], v48 offset:26880
    ds_read_b128 v[76:79], v44 offset:26880
    ds_read_b128 v[80:83], v48
    ds_read_b128 v[84:87], v45
    ds_read_b128 v[88:91], v49 offset:26880
    ds_read_b128 v[92:95], v45 offset:26880
    ds_read_b128 v[96:99], v49
    ds_read_b128 v[100:103], v46
    ds_read_b128 v[104:107], v50 offset:26880
    ds_read_b128 v[108:111], v46 offset:26880
    ds_read_b128 v[112:115], v50
    ds_read_b128 v[116:119], v47
    ds_read_b128 v[120:123], v51 offset:26880
    ds_read_b128 v[124:127], v47 offset:26880
    ds_read_b128 v[40:43], v51
    s_waitcnt lgkmcnt(14)
    v_mfma_f32_32x32x16_bf16 v[16:31], v[68:71], v[72:75], 0
    s_waitcnt lgkmcnt(12)
    v_mfma_f32_32x32x16_bf16 v[16:31], v[76:79], v[80:83], v[16:31]
    v_mfma_f32_32x32x16_bf16 v[16:31], v[68:71], v[80:83], v[16:31]
    s_waitcnt lgkmcnt(10)
    v_mfma_f32_32x32x16_bf16 v[16:31], v[84:87], v[88:91], v[16:31]
    s_waitcnt lgkmcnt(8)
    v_mfma_f32_32x32x16_bf16 v[16:31], v[92:95], v[96:99], v[16:31]
    v_mfma_f32_32x32x16_bf16 v[16:31], v[84:87], v[96:99], v[16:31]
    s_waitcnt lgkmcnt(6)
    v_mfma_f32_32x32x16_bf16 v[16:31], v[100:103], v[104:107], v[16:31]
    s_waitcnt lgkmcnt(4)
    v_mfma_f32_32x32x16_bf16 v[16:31], v[108:111], v[112:115], v[16:31]
    v_mfma_f32_32x32x16_bf16 v[16:31], v[100:103], v[112:115], v[16:31]
    s_waitcnt lgkmcnt(2)
    v_mfma_f32_32x32x16_bf16 v[16:31], v[116:119], v[120:123], v[16:31]
    s_waitcnt lgkmcnt(0)
    v_mfma_f32_32x32x16_bf16 v[16:31], v[124:127], v[40:43], v[16:31]
    v_mfma_f32_32x32x16_bf16 v[16:31], v[116:119], v[40:43], v[16:31]
    v_lshlrev_b32 v7, 4, v2
    v_add_u32 v7, s32, v7
    v_and_b32 v12, 3, v0
    v_mul_u32_u24 v12, 96, v12
    v_lshrrev_b32 v14, 2, v0
    v_add_u32 v12, v12, v14
    v_lshlrev_b32 v12, 4, v12
    s_nop 7
    s_nop 4
    ds_write_b128 v7, v[16:19] offset:512
    ds_write_b128 v7, v[20:23] offset:1536
    ds_write_b128 v7, v[24:27] offset:2560
    s_waitcnt lgkmcnt(0)
    s_barrier
    s_cmp_eq_u32 s3, 3
    s_cbranch_scc1 k1_kg_nored
    ds_read_b128 v[16:19], v5 offset:512
    ds_read_b128 v[20:23], v5 offset:7168
    ds_read_b128 v[24:27], v5 offset:13824
    ds_read_b128 v[28:31], v5 offset:20480
    s_waitcnt lgkmcnt(0)
    v_add_f32 v16, v16, v20
    v_add_f32 v17, v17, v21
    v_add_f32 v18, v18, v22
    v_add_f32 v19, v19, v23
    v_add_f32 v24, v24, v28
    v_add_f32 v25, v25, v29
    v_add_f32 v26, v26, v30
    v_add_f32 v27, v27, v31
    v_add_f32 v16, v16, v24
    v_add_f32 v17, v17, v25
    v_add_f32 v18, v18, v26
    v_add_f32 v19, v19, v27
    ds_write_b128 v5, v[16:19] offset:47360

    s_branch k1_kg_red
k1_kg_nored:
    v_mov_b32 v16, 0
    v_mov_b32 v17, 0
    v_mov_b32 v18, 0
    v_mov_b32 v19, 0
    v_and_b32 v20, 3, v2
    v_lshlrev_b32 v20, 4, v20
    s_mul_i32 s23, s20, 4224
    s_add_u32 s24, s23, 0x108000
    buffer_store_dwordx4 v[16:19], v20, s[8:11], s23 offen
    buffer_store_dwordx4 v[16:19], v20, s[8:11], s24 offen

k1_kg_red:
    s_lshl_b32 s24, s20, 13
    s_waitcnt lgkmcnt(0)
    s_barrier

    ds_read_b32 v16, v60 offset:47360
    ds_read_b32 v17, v61 offset:47360
    ds_read_b32 v18, v62 offset:47360
    ds_read_b32 v19, v63 offset:47360
    ds_read_b32 v20, v64 offset:47360
    ds_read_b32 v21, v65 offset:47360
    ds_read_b32 v22, v66 offset:47360
    ds_read_b32 v23, v67 offset:47360
    s_waitcnt lgkmcnt(0)
    v_cvt_pk_bf16_f32 v32, v16, v17
    v_cvt_pk_bf16_f32 v33, v18, v19
    v_cvt_pk_bf16_f32 v34, v20, v21
    v_cvt_pk_bf16_f32 v35, v22, v23
    s_add_u32 s23, s24, 0x1000
    buffer_store_dwordx4 v[32:35], v5, s[12:15], s24 offen sc0 sc1
    v_lshlrev_b32 v24, 16, v32
    v_and_b32 v25, s35, v32
    v_lshlrev_b32 v26, 16, v33
    v_and_b32 v27, s35, v33
    v_lshlrev_b32 v28, 16, v34
    v_and_b32 v29, s35, v34
    v_lshlrev_b32 v30, 16, v35
    v_and_b32 v31, s35, v35
    v_sub_f32 v16, v16, v24
    v_sub_f32 v17, v17, v25
    v_sub_f32 v18, v18, v26
    v_sub_f32 v19, v19, v27
    v_sub_f32 v20, v20, v28
    v_sub_f32 v21, v21, v29
    v_sub_f32 v22, v22, v30
    v_sub_f32 v23, v23, v31
    v_cvt_pk_bf16_f32 v36, v16, v17
    v_cvt_pk_bf16_f32 v37, v18, v19
    v_cvt_pk_bf16_f32 v38, v20, v21
    v_cvt_pk_bf16_f32 v39, v22, v23
    buffer_store_dwordx4 v[36:39], v5, s[12:15], s23 offen sc0 sc1
    s_branch k1_done
k1_done:
    s_endpgm

.globl k2_kernel
.p2align 8
.type k2_kernel,@function
k2_kernel:
    s_cmp_ge_u32 s2, 752
    s_cbranch_scc1 k2_done
    v_lshrrev_b32 v1, 6, v0
    v_and_b32 v2, 63, v0
    s_load_dwordx2 s[6:7], s[0:1], 112
    v_readfirstlane_b32 s3, v1
    s_cmp_lt_u32 s2, 240
    s_cbranch_scc1 k2_gemm

    s_cmp_ge_u32 s2, 496
    s_cbranch_scc1 k2_cvB

    s_load_dwordx2 s[4:5], s[0:1], 64
    s_load_dwordx2 s[56:57], s[0:1], 88
    s_sub_u32 s20, s2, 240
    v_and_b32 v4, 31, v2
    v_lshrrev_b32 v6, 5, v2
    s_and_b32 s21, s20, 0x1fe
    s_lshl_b32 s21, s21, 1
    s_mul_i32 s23, s20, 4224
    s_add_u32 s26, s23, 48
    s_lshl_b32 s27, s20, 13
    v_lshlrev_b32 v5, 4, v0
    v_lshlrev_b32 v3, 5, v0
    s_waitcnt lgkmcnt(0)
    s_load_dword s22, s[4:5], s21

    s_add_u32 s8, s6, 0x200000
    s_addc_u32 s9, s7, 0
    s_and_b32 s9, s9, 0xffff
    s_mov_b32 s10, 0x211000
    s_mov_b32 s11, 0x00020000

    s_add_u32 s12, s6, 0x620000
    s_addc_u32 s13, s7, 0
    s_and_b32 s13, s13, 0xffff
    s_mov_b32 s14, 0x400000
    s_mov_b32 s15, 0x00020000

    buffer_load_dwordx4 v[32:35], v5, s[8:11], s26 offen
    buffer_load_dwordx4 v[36:39], v5, s[8:11], s26 offen offset:16
    s_add_u32 s28, s27, 0x1000
    buffer_load_dwordx4 v[60:63], v5, s[12:15], s27 offen
    buffer_load_dwordx4 v[64:67], v5, s[12:15], s28 offen

    s_setprio 2
    s_add_u32 s16, s6, 0xa20000
    s_addc_u32 s17, s7, 0
    s_and_b32 s17, s17, 0xffff
    s_mov_b32 s18, 0x200000
    s_mov_b32 s19, 0x00020000

    v_and_b32 v15, 3, v0
    v_mul_u32_u24 v15, 96, v15
    v_lshrrev_b32 v14, 2, v0
    v_add_u32 v15, v15, v14
    v_lshlrev_b32 v15, 4, v15
    v_mov_b32 v20, 0
    v_mov_b32 v21, 0
    v_mov_b32 v22, 0
    v_mov_b32 v23, 0
    s_cmp_eq_u32 s3, 3
    s_cbranch_scc1 k2_ca_zf
    s_cmp_ge_u32 s3, 2
    s_cbranch_scc1 k2_ca_nozero
    ds_write_b128 v15, v[20:23] offset:36096
    ds_write_b128 v15, v[20:23] offset:42240
    s_branch k2_ca_nozero

k2_ca_zf:
    v_lshrrev_b32 v16, 3, v2
    v_min_u32 v16, 2, v16
    v_lshlrev_b32 v16, 4, v16
    v_and_b32 v17, 7, v2
    v_mov_b32 v18, 4384
    v_mad_u32_u24 v16, v17, v18, v16
    ds_write_b128 v16, v[20:23]

k2_ca_nozero:
    s_lshl_b32 s35, s3, 4
    v_lshrrev_b32 v12, 3, v4
    v_add_u32 v12, v12, v6
    v_lshlrev_b32 v12, 4, v12
    v_and_b32 v13, 7, v4
    v_mov_b32 v14, 4384
    v_mad_u32_u24 v12, v13, v14, v12
    s_lshl_b32 s36, s35, 5
    v_add_u32 v12, s36, v12
    v_mul_u32_u24 v13, 96, v6
    v_sub_u32 v13, v13, v4
    v_add_u32 v13, 31, v13
    v_lshlrev_b32 v13, 4, v13
    s_lshl_b32 s36, s35, 3
    s_add_u32 s36, s36, 35072
    v_add_u32 v13, s36, v13

    s_waitcnt vmcnt(2)
    ds_write_b128 v5, v[34:37] offset:13200
    ds_write_b128 v5, v[36:39] offset:30736
    v_alignbit_b32 v40, v33, v32, 16
    v_alignbit_b32 v41, v34, v33, 16
    v_alignbit_b32 v42, v35, v34, 16
    v_alignbit_b32 v43, v36, v35, 16
    v_alignbit_b32 v44, v37, v36, 16
    v_alignbit_b32 v45, v38, v37, 16
    ds_write_b128 v5, v[40:43] offset:48
    ds_write_b128 v5, v[42:45] offset:17584
    v_mov_b32 v48, v33
    v_mov_b32 v49, v34
    v_mov_b32 v50, v35
    v_mov_b32 v51, v36
    v_mov_b32 v52, v37
    v_mov_b32 v53, v38
    ds_write_b128 v5, v[48:51] offset:4432
    ds_write_b128 v5, v[50:53] offset:21968
    v_alignbit_b32 v54, v34, v33, 16
    v_alignbit_b32 v55, v35, v34, 16
    v_alignbit_b32 v56, v36, v35, 16
    v_alignbit_b32 v57, v37, v36, 16
    v_alignbit_b32 v58, v38, v37, 16
    v_alignbit_b32 v59, v39, v38, 16
    ds_write_b128 v5, v[54:57] offset:8816
    ds_write_b128 v5, v[56:59] offset:26352
    v_mov_b32 v8, v36
    v_mov_b32 v9, v37
    v_mov_b32 v10, v38
    v_mov_b32 v11, v39
    s_waitcnt vmcnt(1)
    ds_write_b128 v15, v[60:63] offset:35072
    s_waitcnt vmcnt(0)
    ds_write_b128 v15, v[64:67] offset:41216

    s_branch k2_cv_join
k2_cvB:
    s_load_dwordx2 s[4:5], s[0:1], 64
    s_load_dwordx8 s[40:47], s[0:1], 8
    s_load_dwordx4 s[48:51], s[0:1], 40
    s_load_dwordx2 s[52:53], s[0:1], 56
    s_load_dwordx2 s[56:57], s[0:1], 88
    s_load_dwordx2 s[90:91], s[0:1], 80
    s_sub_u32 s20, s2, 240
    s_lshl_b32 s27, s20, 8
    s_lshl_b32 s28, s3, 6
    s_add_u32 s27, s27, s28
    v_and_b32 v4, 31, v2
    v_lshrrev_b32 v6, 5, v2
    v_lshlrev_b32 v7, 1, v4
    v_add_u32 v7, s27, v7
    s_lshl_b32 s27, s20, 1
    v_mov_b32 v14, s27
    s_waitcnt lgkmcnt(0)
    global_load_ushort v80, v7, s[40:41]
    global_load_ushort v81, v7, s[42:43]
    global_load_ushort v82, v7, s[44:45]
    global_load_ushort v83, v7, s[46:47]
    global_load_ushort v84, v7, s[48:49]
    global_load_ushort v85, v7, s[50:51]
    global_load_ushort v86, v14, s[52:53]
    s_and_b32 s21, s20, 0x1fe
    s_lshl_b32 s21, s21, 1
    s_load_dword s22, s[4:5], s21

    s_setprio 2
    s_add_u32 s8, s6, 0x200000
    s_addc_u32 s9, s7, 0
    s_and_b32 s9, s9, 0xffff
    s_mov_b32 s10, 0x211000
    s_mov_b32 s11, 0x00020000

    s_add_u32 s16, s6, 0xa20000
    s_addc_u32 s17, s7, 0
    s_and_b32 s17, s17, 0xffff
    s_mov_b32 s18, 0x200000
    s_mov_b32 s19, 0x00020000

    s_add_u32 s12, s6, 0x420000
    s_addc_u32 s13, s7, 0
    s_and_b32 s13, s13, 0xffff
    s_mov_b32 s14, 0x2000
    s_mov_b32 s15, 0x00020000

    s_mul_i32 s23, s20, 4224
    s_add_u32 s26, s23, 48
    v_lshlrev_b32 v5, 4, v0
    v_lshlrev_b32 v3, 5, v0
    buffer_load_dwordx4 v[60:63], v3, s[12:15], 0 offen
    buffer_load_dwordx4 v[64:67], v3, s[12:15], 0 offen offset:16

    s_mov_b32 s54, 0
    s_mov_b32 s55, -1
    s_mul_i32 s32, s3, 6656
    v_lshlrev_b32 v12, 12, v6
    v_add_u32 v12, s32, v12
    v_and_b32 v13, 3, v4
    v_lshl_add_u32 v12, v13, 2, v12
    v_lshrrev_b32 v13, 2, v4
    v_lshl_add_u32 v12, v13, 4, v12

    v_xor_b32 v40, 0, v12
    v_xor_b32 v41, 128, v12
    v_xor_b32 v42, 16, v12
    v_xor_b32 v43, 144, v12
    v_xor_b32 v44, 32, v12
    v_xor_b32 v45, 160, v12
    v_xor_b32 v46, 48, v12
    v_xor_b32 v47, 176, v12
    v_xor_b32 v48, 64, v12
    v_xor_b32 v49, 192, v12
    v_xor_b32 v50, 80, v12
    v_xor_b32 v51, 208, v12
    v_xor_b32 v52, 96, v12
    v_xor_b32 v53, 224, v12
    v_xor_b32 v54, 112, v12
    v_xor_b32 v55, 240, v12
    v_mov_b32 v13, s32
    v_cndmask_b32 v13, v13, 0, s[54:55]
    v_sub_u32 v56, v12, v13
    v_mov_b32 v14, 0x41000000
    v_cndmask_b32 v12, v14, 1.0, s[54:55]
    v_cndmask_b32 v13, v14, -1.0, s[54:55]
    v_mov_b32 v14, 0x42800000
    v_mov_b32 v15, 0x43800000
    v_cndmask_b32 v57, v14, v15, s[54:55]
    v_cndmask_b32 v58, v14, -v15, s[54:55]
    s_mov_b32 s33, 0x3fb8aa3b
    s_mov_b32 s34, 0x3e22f983
    s_mov_b32 s35, 0xffff0000
    s_mov_b32 s36, 0x0000bf80
    s_mov_b32 s37, 0x80000000
    s_waitcnt vmcnt(2)

    v_lshlrev_b32 v86, 16, v86
    v_mul_f32 v86, s33, v86
    v_exp_f32 v86, v86
    v_lshlrev_b32 v80, 16, v80
    v_lshlrev_b32 v81, 16, v81
    v_lshlrev_b32 v82, 16, v82
    v_lshlrev_b32 v83, 16, v83
    v_lshlrev_b32 v84, 16, v84
    v_lshlrev_b32 v85, 16, v85
    v_cvt_pk_bf16_f32 v86, v86, v86
    v_and_b32 v86, s35, v86
    v_mul_f32 v80, v86, v80
    v_mul_f32 v81, v86, v81
    v_mul_f32 v82, v86, v82
    v_mul_f32 v83, v86, v83
    v_mul_f32 v88, s33, v80
    v_mul_f32 v89, s34, v81
    v_mul_f32 v68, v88, v12
    v_mul_f32 v69, v89, v13
    v_mul_f32 v70, v88, v57
    v_mul_f32 v71, v89, v58
    v_exp_f32 v68, v68
    v_fract_f32 v69, v69
    v_exp_f32 v70, v70
    v_fract_f32 v71, v71
    v_cos_f32 v92, v69
    v_sin_f32 v93, v69
    v_cos_f32 v106, v71
    v_sin_f32 v107, v71
    v_mul_f32 v90, v84, v82
    v_fma_f32 v90, -v85, v83, v90
    v_mul_f32 v91, v84, v83
    v_fma_f32 v91, v85, v82, v91
    v_mul_f32 v92, v68, v92
    v_mul_f32 v93, v68, v93
    v_mul_f32 v106, v70, v106
    v_mul_f32 v107, v70, v107
    v_cndmask_b32 v114, 1.0, v90, s[54:55]
    v_cndmask_b32 v115, 0, -v91, s[54:55]

    v_mul_f32 v94, v92, v92
    v_mul_f32 v95, v92, v93
    v_mul_f32 v108, v106, v106
    v_mul_f32 v109, v106, v107
    v_fma_f32 v94, -v93, v93, v94
    v_fmac_f32 v95, v93, v92
    v_fma_f32 v108, -v107, v107, v108
    v_fmac_f32 v109, v107, v106

    v_mul_f32 v96, v94, v92
    v_mul_f32 v97, v94, v93
    v_mul_f32 v110, v108, v106
    v_mul_f32 v111, v108, v107
    v_fma_f32 v96, -v95, v93, v96
    v_fmac_f32 v97, v95, v92
    v_fma_f32 v110, -v109, v107, v110
    v_fmac_f32 v111, v109, v106

    v_mul_f32 v98, v94, v94
    v_mul_f32 v99, v94, v95
    v_mul_f32 v116, v114, v106
    v_mul_f32 v117, v114, v107
    v_fma_f32 v98, -v95, v95, v98
    v_fmac_f32 v99, v95, v94
    v_fma_f32 v116, -v115, v107, v116
    v_fmac_f32 v117, v115, v106

    v_mul_f32 v102, v96, v96
    v_mul_f32 v103, v96, v97
    v_mul_f32 v112, v110, v110
    v_mul_f32 v113, v110, v111
    v_fma_f32 v102, -v97, v97, v102
    v_fmac_f32 v103, v97, v96
    v_fma_f32 v112, -v111, v111, v112
    v_fmac_f32 v113, v111, v110

    v_mul_f32 v100, v98, v92
    v_mul_f32 v101, v98, v93
    v_mul_f32 v118, v114, v108
    v_mul_f32 v119, v114, v109
    v_fma_f32 v100, -v99, v93, v100
    v_fmac_f32 v101, v99, v92
    v_fma_f32 v118, -v115, v109, v118
    v_fmac_f32 v119, v115, v108

    v_mul_f32 v104, v98, v96
    v_mul_f32 v105, v98, v97
    v_mul_f32 v120, v114, v110
    v_mul_f32 v121, v114, v111
    v_fma_f32 v104, -v99, v97, v104
    v_fmac_f32 v105, v99, v96
    v_fma_f32 v120, -v115, v111, v120
    v_fmac_f32 v121, v115, v110

    v_cndmask_b32 v122, v92, v110, s[54:55]
    v_cndmask_b32 v123, v93, v111, s[54:55]
    v_cndmask_b32 v124, v96, v112, s[54:55]
    v_cndmask_b32 v125, v97, v113, s[54:55]
    v_xor_b32 v84, s37, v115
    v_xor_b32 v85, s37, v117
    v_xor_b32 v86, s37, v119
    v_xor_b32 v87, s37, v121

    v_mul_f32 v72, v114, v92
    v_mul_f32 v73, v114, v93
    v_fmac_f32 v72, v84, v93
    v_fmac_f32 v73, v115, v92
    v_cvt_pk_bf16_f32 v70, v114, v115
    v_cvt_pk_bf16_f32 v74, v72, v73
    v_lshlrev_b32 v88, 16, v70
    v_and_b32 v89, s35, v70
    v_lshlrev_b32 v90, 16, v74
    v_and_b32 v91, s35, v74
    v_sub_f32 v68, v114, v88
    v_sub_f32 v69, v115, v89
    v_sub_f32 v72, v72, v90
    v_sub_f32 v73, v73, v91
    v_mul_f32 v76, v114, v94
    v_mul_f32 v77, v114, v95
    v_mul_f32 v80, v114, v96
    v_mul_f32 v81, v114, v97
    v_fmac_f32 v76, v84, v95
    v_fmac_f32 v77, v115, v94
    v_fmac_f32 v80, v84, v97
    v_fmac_f32 v81, v115, v96
    v_cvt_pk_bf16_f32 v71, v68, v69
    v_cvt_pk_bf16_f32 v75, v72, v73
    ds_write2st64_b32 v56, v70, v71 offset0:0 offset1:105
    ds_write2st64_b32 v41, v74, v75 offset0:0 offset1:105
    v_cvt_pk_bf16_f32 v78, v76, v77
    v_cvt_pk_bf16_f32 v82, v80, v81
    v_lshlrev_b32 v88, 16, v78
    v_and_b32 v89, s35, v78
    v_lshlrev_b32 v90, 16, v82
    v_and_b32 v91, s35, v82
    v_sub_f32 v76, v76, v88
    v_sub_f32 v77, v77, v89
    v_sub_f32 v80, v80, v90
    v_sub_f32 v81, v81, v91
    v_mul_f32 v68, v114, v98
    v_mul_f32 v69, v114, v99
    v_mul_f32 v72, v114, v100
    v_mul_f32 v73, v114, v101
    v_fmac_f32 v68, v84, v99
    v_fmac_f32 v69, v115, v98
    v_fmac_f32 v72, v84, v101
    v_fmac_f32 v73, v115, v100
    v_cvt_pk_bf16_f32 v79, v76, v77
    v_cvt_pk_bf16_f32 v83, v80, v81
    ds_write2st64_b32 v42, v78, v79 offset0:1 offset1:106
    ds_write2st64_b32 v43, v82, v83 offset0:1 offset1:106
    v_cvt_pk_bf16_f32 v70, v68, v69
    v_cvt_pk_bf16_f32 v74, v72, v73
    v_lshlrev_b32 v88, 16, v70
    v_and_b32 v89, s35, v70
    v_lshlrev_b32 v90, 16, v74
    v_and_b32 v91, s35, v74
    v_sub_f32 v68, v68, v88
    v_sub_f32 v69, v69, v89
    v_sub_f32 v72, v72, v90
    v_sub_f32 v73, v73, v91
    v_mul_f32 v76, v114, v102
    v_mul_f32 v77, v114, v103
    v_mul_f32 v80, v114, v104
    v_mul_f32 v81, v114, v105
    v_fmac_f32 v76, v84, v103
    v_fmac_f32 v77, v115, v102
    v_fmac_f32 v80, v84, v105
    v_fmac_f32 v81, v115, v104
    v_cvt_pk_bf16_f32 v71, v68, v69
    v_cvt_pk_bf16_f32 v75, v72, v73
    ds_write2st64_b32 v44, v70, v71 offset0:2 offset1:107
    ds_write2st64_b32 v45, v74, v75 offset0:2 offset1:107
    v_cvt_pk_bf16_f32 v78, v76, v77
    v_cvt_pk_bf16_f32 v82, v80, v81
    v_lshlrev_b32 v88, 16, v78
    v_and_b32 v89, s35, v78
    v_lshlrev_b32 v90, 16, v82
    v_and_b32 v91, s35, v82
    v_sub_f32 v76, v76, v88
    v_sub_f32 v77, v77, v89
    v_sub_f32 v80, v80, v90
    v_sub_f32 v81, v81, v91
    v_mul_f32 v72, v116, v94
    v_mul_f32 v73, v116, v95
    v_fmac_f32 v72, v85, v95
    v_fmac_f32 v73, v117, v94
    v_cvt_pk_bf16_f32 v79, v76, v77
    v_cvt_pk_bf16_f32 v83, v80, v81
    ds_write2st64_b32 v46, v78, v79 offset0:3 offset1:108
    ds_write2st64_b32 v47, v82, v83 offset0:3 offset1:108
    v_cvt_pk_bf16_f32 v70, v116, v117
    v_cvt_pk_bf16_f32 v74, v72, v73
    v_lshlrev_b32 v88, 16, v70
    v_and_b32 v89, s35, v70
    v_lshlrev_b32 v90, 16, v74
    v_and_b32 v91, s35, v74
    v_sub_f32 v68, v116, v88
    v_sub_f32 v69, v117, v89
    v_sub_f32 v72, v72, v90
    v_sub_f32 v73, v73, v91
    v_mul_f32 v76, v116, v98
    v_mul_f32 v77, v116, v99
    v_mul_f32 v80, v116, v102
    v_mul_f32 v81, v116, v103
    v_fmac_f32 v76, v85, v99
    v_fmac_f32 v77, v117, v98
    v_fmac_f32 v80, v85, v103
    v_fmac_f32 v81, v117, v102
    v_cvt_pk_bf16_f32 v71, v68, v69
    v_cvt_pk_bf16_f32 v75, v72, v73
    ds_write2st64_b32 v48, v70, v71 offset0:4 offset1:109
    ds_write2st64_b32 v49, v74, v75 offset0:4 offset1:109
    v_cvt_pk_bf16_f32 v78, v76, v77
    v_cvt_pk_bf16_f32 v82, v80, v81
    v_lshlrev_b32 v88, 16, v78
    v_and_b32 v89, s35, v78
    v_lshlrev_b32 v90, 16, v82
    v_and_b32 v91, s35, v82
    v_sub_f32 v76, v76, v88
    v_sub_f32 v77, v77, v89
    v_sub_f32 v80, v80, v90
    v_sub_f32 v81, v81, v91
    v_mul_f32 v68, v116, v122
    v_mul_f32 v69, v116, v123
    v_mul_f32 v72, v116, v124
    v_mul_f32 v73, v116, v125
    v_fmac_f32 v68, v85, v123
    v_fmac_f32 v69, v117, v122
    v_fmac_f32 v72, v85, v125
    v_fmac_f32 v73, v117, v124
    v_cvt_pk_bf16_f32 v79, v76, v77
    v_cvt_pk_bf16_f32 v83, v80, v81
    ds_write2st64_b32 v50, v78, v79 offset0:5 offset1:110
    ds_write2st64_b32 v51, v82, v83 offset0:5 offset1:110
    v_cvt_pk_bf16_f32 v70, v68, v69
    v_cvt_pk_bf16_f32 v74, v72, v73
    v_lshlrev_b32 v88, 16, v70
    v_and_b32 v89, s35, v70
    v_lshlrev_b32 v90, 16, v74
    v_and_b32 v91, s35, v74
    v_sub_f32 v68, v68, v88
    v_sub_f32 v69, v69, v89
    v_sub_f32 v72, v72, v90
    v_sub_f32 v73, v73, v91
    v_mul_f32 v80, v118, v98
    v_mul_f32 v81, v118, v99
    v_fmac_f32 v80, v86, v99
    v_fmac_f32 v81, v119, v98
    v_cvt_pk_bf16_f32 v71, v68, v69
    v_cvt_pk_bf16_f32 v75, v72, v73
    ds_write2st64_b32 v52, v70, v71 offset0:6 offset1:111
    ds_write2st64_b32 v53, v74, v75 offset0:6 offset1:111
    v_cvt_pk_bf16_f32 v78, v118, v119
    v_cvt_pk_bf16_f32 v82, v80, v81
    v_lshlrev_b32 v88, 16, v78
    v_and_b32 v89, s35, v78
    v_lshlrev_b32 v90, 16, v82
    v_and_b32 v91, s35, v82
    v_sub_f32 v76, v118, v88
    v_sub_f32 v77, v119, v89
    v_sub_f32 v80, v80, v90
    v_sub_f32 v81, v81, v91
    v_mul_f32 v68, v118, v122
    v_mul_f32 v69, v118, v123
    v_mul_f32 v72, v118, v124
    v_mul_f32 v73, v118, v125
    v_fmac_f32 v68, v86, v123
    v_fmac_f32 v69, v119, v122
    v_fmac_f32 v72, v86, v125
    v_fmac_f32 v73, v119, v124
    v_cvt_pk_bf16_f32 v79, v76, v77
    v_cvt_pk_bf16_f32 v83, v80, v81
    ds_write2st64_b32 v54, v78, v79 offset0:7 offset1:112
    ds_write2st64_b32 v55, v82, v83 offset0:7 offset1:112
    v_cvt_pk_bf16_f32 v70, v68, v69
    v_cvt_pk_bf16_f32 v74, v72, v73
    v_lshlrev_b32 v88, 16, v70
    v_and_b32 v89, s35, v70
    v_lshlrev_b32 v90, 16, v74
    v_and_b32 v91, s35, v74
    v_sub_f32 v68, v68, v88
    v_sub_f32 v69, v69, v89
    v_sub_f32 v72, v72, v90
    v_sub_f32 v73, v73, v91
    v_mul_f32 v80, v120, v98
    v_mul_f32 v81, v120, v99
    v_fmac_f32 v80, v87, v99
    v_fmac_f32 v81, v121, v98
    v_cvt_pk_bf16_f32 v71, v68, v69
    v_cvt_pk_bf16_f32 v75, v72, v73
    ds_write2st64_b32 v40, v70, v71 offset0:8 offset1:113
    ds_write2st64_b32 v41, v74, v75 offset0:8 offset1:113
    v_cvt_pk_bf16_f32 v78, v120, v121
    v_cvt_pk_bf16_f32 v82, v80, v81
    v_lshlrev_b32 v88, 16, v78
    v_and_b32 v89, s35, v78
    v_lshlrev_b32 v90, 16, v82
    v_and_b32 v91, s35, v82
    v_sub_f32 v76, v120, v88
    v_sub_f32 v77, v121, v89
    v_sub_f32 v80, v80, v90
    v_sub_f32 v81, v81, v91
    v_mul_f32 v68, v120, v122
    v_mul_f32 v69, v120, v123
    v_mul_f32 v72, v116, v100
    v_mul_f32 v73, v116, v101
    v_fmac_f32 v68, v87, v123
    v_fmac_f32 v69, v121, v122
    v_fmac_f32 v72, v85, v101
    v_fmac_f32 v73, v117, v100
    v_cvt_pk_bf16_f32 v79, v76, v77
    v_cvt_pk_bf16_f32 v83, v80, v81
    ds_write2st64_b32 v42, v78, v79 offset0:9 offset1:114
    ds_write2st64_b32 v43, v82, v83 offset0:9 offset1:114
    v_cvt_pk_bf16_f32 v70, v68, v69
    v_cvt_pk_bf16_f32 v74, v72, v73
    v_lshlrev_b32 v88, 16, v70
    v_and_b32 v89, s35, v70
    v_lshlrev_b32 v90, 16, v74
    v_and_b32 v91, s35, v74
    v_sub_f32 v68, v68, v88
    v_sub_f32 v69, v69, v89
    v_sub_f32 v72, v72, v90
    v_sub_f32 v73, v73, v91
    v_mul_f32 v76, v116, v104
    v_mul_f32 v77, v116, v105
    v_mul_f32 v80, v118, v94
    v_mul_f32 v81, v118, v95
    v_fmac_f32 v76, v85, v105
    v_fmac_f32 v77, v117, v104
    v_fmac_f32 v80, v86, v95
    v_fmac_f32 v81, v119, v94
    v_cvt_pk_bf16_f32 v71, v68, v69
    v_cvt_pk_bf16_f32 v75, v72, v73
    ds_write2st64_b32 v44, v70, v71 offset0:10 offset1:115
    s_mov_b32 exec_hi, 0
    ds_write2st64_b32 v45, v74, v75 offset0:10 offset1:115
    v_cvt_pk_bf16_f32 v78, v76, v77
    v_cvt_pk_bf16_f32 v82, v80, v81
    v_lshlrev_b32 v88, 16, v78
    v_and_b32 v89, s35, v78
    v_lshlrev_b32 v90, 16, v82
    v_and_b32 v91, s35, v82
    v_sub_f32 v76, v76, v88
    v_sub_f32 v77, v77, v89
    v_sub_f32 v80, v80, v90
    v_sub_f32 v81, v81, v91
    v_mul_f32 v68, v118, v100
    v_mul_f32 v69, v118, v101
    v_mul_f32 v72, v118, v102
    v_mul_f32 v73, v118, v103
    v_fmac_f32 v68, v86, v101
    v_fmac_f32 v69, v119, v100
    v_fmac_f32 v72, v86, v103
    v_fmac_f32 v73, v119, v102
    v_cvt_pk_bf16_f32 v79, v76, v77
    v_cvt_pk_bf16_f32 v83, v80, v81
    ds_write2st64_b32 v46, v78, v79 offset0:11 offset1:116
    ds_write2st64_b32 v47, v82, v83 offset0:11 offset1:116
    v_cvt_pk_bf16_f32 v70, v68, v69
    v_cvt_pk_bf16_f32 v74, v72, v73
    v_lshlrev_b32 v88, 16, v70
    v_and_b32 v89, s35, v70
    v_lshlrev_b32 v90, 16, v74
    v_and_b32 v91, s35, v74
    v_sub_f32 v68, v68, v88
    v_sub_f32 v69, v69, v89
    v_sub_f32 v72, v72, v90
    v_sub_f32 v73, v73, v91
    v_mul_f32 v76, v118, v104
    v_mul_f32 v77, v118, v105
    v_mul_f32 v80, v120, v94
    v_mul_f32 v81, v120, v95
    v_fmac_f32 v76, v86, v105
    v_fmac_f32 v77, v119, v104
    v_fmac_f32 v80, v87, v95
    v_fmac_f32 v81, v121, v94
    v_cvt_pk_bf16_f32 v71, v68, v69
    v_cvt_pk_bf16_f32 v75, v72, v73
    ds_write2st64_b32 v48, v70, v71 offset0:12 offset1:117
    ds_write2st64_b32 v49, v74, v75 offset0:12 offset1:117
    v_cvt_pk_bf16_f32 v78, v76, v77
    v_cvt_pk_bf16_f32 v82, v80, v81
    v_lshlrev_b32 v88, 16, v78
    v_and_b32 v89, s35, v78
    v_lshlrev_b32 v90, 16, v82
    v_and_b32 v91, s35, v82
    v_sub_f32 v76, v76, v88
    v_sub_f32 v77, v77, v89
    v_sub_f32 v80, v80, v90
    v_sub_f32 v81, v81, v91
    v_mul_f32 v68, v120, v124
    v_mul_f32 v69, v120, v125
    v_mul_f32 v72, v120, v100
    v_mul_f32 v73, v120, v101
    v_fmac_f32 v68, v87, v125
    v_fmac_f32 v69, v121, v124
    v_fmac_f32 v72, v87, v101
    v_fmac_f32 v73, v121, v100
    v_cvt_pk_bf16_f32 v79, v76, v77
    v_cvt_pk_bf16_f32 v83, v80, v81
    ds_write2st64_b32 v50, v78, v79 offset0:13 offset1:118
    ds_write2st64_b32 v51, v82, v83 offset0:13 offset1:118
    v_cvt_pk_bf16_f32 v70, v68, v69
    v_cvt_pk_bf16_f32 v74, v72, v73
    v_lshlrev_b32 v88, 16, v70
    v_and_b32 v89, s35, v70
    v_lshlrev_b32 v90, 16, v74
    v_and_b32 v91, s35, v74
    v_sub_f32 v68, v68, v88
    v_sub_f32 v69, v69, v89
    v_sub_f32 v72, v72, v90
    v_sub_f32 v73, v73, v91
    v_mul_f32 v76, v120, v102
    v_mul_f32 v77, v120, v103
    v_mul_f32 v80, v120, v104
    v_mul_f32 v81, v120, v105
    v_fmac_f32 v76, v87, v103
    v_fmac_f32 v77, v121, v102
    v_fmac_f32 v80, v87, v105
    v_fmac_f32 v81, v121, v104
    v_cvt_pk_bf16_f32 v71, v68, v69
    v_cvt_pk_bf16_f32 v75, v72, v73
    ds_write2st64_b32 v52, v70, v71 offset0:14 offset1:119
    ds_write2st64_b32 v53, v74, v75 offset0:14 offset1:119
    v_cvt_pk_bf16_f32 v78, v76, v77
    v_cvt_pk_bf16_f32 v82, v80, v81
    v_lshlrev_b32 v88, 16, v78
    v_and_b32 v89, s35, v78
    v_lshlrev_b32 v90, 16, v82
    v_and_b32 v91, s35, v82
    v_sub_f32 v76, v76, v88
    v_sub_f32 v77, v77, v89
    v_sub_f32 v80, v80, v90
    v_sub_f32 v81, v81, v91
    v_cvt_pk_bf16_f32 v79, v76, v77
    v_cvt_pk_bf16_f32 v83, v80, v81
    ds_write2st64_b32 v54, v78, v79 offset0:15 offset1:120
    ds_write2st64_b32 v55, v82, v83 offset0:15 offset1:120
    s_mov_b64 exec, -1
    v_min_u32 v12, 20, v4
    v_bfe_u32 v13, v12, 1, 3
    v_xor_b32 v13, v13, v6
    v_lshlrev_b32 v13, 4, v13
    v_lshl_add_u32 v12, v12, 7, v13
    s_add_u32 s33, s32, 4096
    v_add_u32 v44, s33, v12
    v_bfe_u32 v13, v4, 1, 3
    v_xor_b32 v13, v13, v6
    v_lshlrev_b32 v13, 4, v13
    v_lshl_add_u32 v12, v4, 7, v13
    v_mov_b32 v14, s32
    v_cmp_eq_u32 vcc, 0, v4
    v_xor_b32 v45, 32, v44
    v_cndmask_b32 v14, v14, 0, vcc
    v_add_u32 v48, v14, v12
    v_xor_b32 v46, 64, v44
    v_xor_b32 v47, 96, v44
    v_xor_b32 v49, 32, v48
    v_xor_b32 v50, 64, v48
    v_xor_b32 v51, 96, v48
    s_waitcnt lgkmcnt(0)

    ds_read_b128 v[68:71], v44
    ds_read_b128 v[72:75], v48 offset:26880
    ds_read_b128 v[76:79], v44 offset:26880
    ds_read_b128 v[80:83], v48
    ds_read_b128 v[84:87], v45
    ds_read_b128 v[88:91], v49 offset:26880
    ds_read_b128 v[92:95], v45 offset:26880
    ds_read_b128 v[96:99], v49
    ds_read_b128 v[100:103], v46
    ds_read_b128 v[104:107], v50 offset:26880
    ds_read_b128 v[108:111], v46 offset:26880
    ds_read_b128 v[112:115], v50
    ds_read_b128 v[116:119], v47
    ds_read_b128 v[120:123], v51 offset:26880
    ds_read_b128 v[124:127], v47 offset:26880
    ds_read_b128 v[40:43], v51
    s_waitcnt lgkmcnt(14)
    v_mfma_f32_32x32x16_bf16 v[16:31], v[68:71], v[72:75], 0
    s_waitcnt lgkmcnt(12)
    v_mfma_f32_32x32x16_bf16 v[16:31], v[76:79], v[80:83], v[16:31]
    v_mfma_f32_32x32x16_bf16 v[16:31], v[68:71], v[80:83], v[16:31]
    s_waitcnt lgkmcnt(10)
    v_mfma_f32_32x32x16_bf16 v[16:31], v[84:87], v[88:91], v[16:31]
    s_waitcnt lgkmcnt(8)
    v_mfma_f32_32x32x16_bf16 v[16:31], v[92:95], v[96:99], v[16:31]
    v_mfma_f32_32x32x16_bf16 v[16:31], v[84:87], v[96:99], v[16:31]
    s_waitcnt lgkmcnt(6)
    v_mfma_f32_32x32x16_bf16 v[16:31], v[100:103], v[104:107], v[16:31]
    s_waitcnt lgkmcnt(4)
    v_mfma_f32_32x32x16_bf16 v[16:31], v[108:111], v[112:115], v[16:31]
    v_mfma_f32_32x32x16_bf16 v[16:31], v[100:103], v[112:115], v[16:31]
    s_waitcnt lgkmcnt(2)
    v_mfma_f32_32x32x16_bf16 v[16:31], v[116:119], v[120:123], v[16:31]
    s_waitcnt lgkmcnt(0)
    v_mfma_f32_32x32x16_bf16 v[16:31], v[124:127], v[40:43], v[16:31]
    v_mfma_f32_32x32x16_bf16 v[16:31], v[116:119], v[40:43], v[16:31]
    v_lshlrev_b32 v7, 4, v2
    v_add_u32 v7, s32, v7
    v_and_b32 v12, 3, v0
    v_mul_u32_u24 v12, 96, v12
    v_lshrrev_b32 v14, 2, v0
    v_add_u32 v12, v12, v14
    v_lshlrev_b32 v12, 4, v12
    s_nop 7
    s_nop 4
    ds_write_b128 v7, v[16:19] offset:512
    ds_write_b128 v7, v[20:23] offset:1536
    ds_write_b128 v7, v[24:27] offset:2560
    s_waitcnt lgkmcnt(0)
    s_barrier
    s_cmp_eq_u32 s3, 3
    s_cbranch_scc1 k2_cv_nored
    ds_read_b128 v[16:19], v5 offset:512
    ds_read_b128 v[20:23], v5 offset:7168
    ds_read_b128 v[24:27], v5 offset:13824
    ds_read_b128 v[28:31], v5 offset:20480
    s_waitcnt lgkmcnt(0)
    v_add_f32 v16, v16, v20
    v_add_f32 v17, v17, v21
    v_add_f32 v18, v18, v22
    v_add_f32 v19, v19, v23
    v_add_f32 v24, v24, v28
    v_add_f32 v25, v25, v29
    v_add_f32 v26, v26, v30
    v_add_f32 v27, v27, v31
    v_add_f32 v16, v16, v24
    v_add_f32 v17, v17, v25
    v_add_f32 v18, v18, v26
    v_add_f32 v19, v19, v27
    ds_write_b128 v5, v[16:19] offset:47360

k2_cv_nored:
    s_waitcnt vmcnt(0)
    s_waitcnt lgkmcnt(0)
    s_barrier

    ds_read_b32 v16, v60 offset:47360
    ds_read_b32 v17, v61 offset:47360
    ds_read_b32 v18, v62 offset:47360
    ds_read_b32 v19, v63 offset:47360
    ds_read_b32 v20, v64 offset:47360
    ds_read_b32 v21, v65 offset:47360
    ds_read_b32 v22, v66 offset:47360
    ds_read_b32 v23, v67 offset:47360
    s_add_u32 s12, s6, 0x620000
    s_addc_u32 s13, s7, 0
    s_and_b32 s13, s13, 0xffff
    s_mov_b32 s14, 0x400000
    s_mov_b32 s15, 0x00020000

    s_mov_b32 s56, s56
    s_and_b32 s57, s57, 0xffff
    s_mov_b32 s58, 0x158000
    s_mov_b32 s59, 0x00020000

    s_lshl_b32 s36, s20, 12
    v_add_u32 v72, s36, v5
    buffer_load_dwordx4 v[68:71], v72, s[56:59], 0 offen
    s_lshl_b32 s24, s20, 13
    s_waitcnt lgkmcnt(0)

    v_cvt_pk_bf16_f32 v32, v16, v17
    v_cvt_pk_bf16_f32 v33, v18, v19
    v_cvt_pk_bf16_f32 v34, v20, v21
    v_cvt_pk_bf16_f32 v35, v22, v23
    v_lshlrev_b32 v24, 16, v32
    v_and_b32 v25, s35, v32
    v_lshlrev_b32 v26, 16, v33
    v_and_b32 v27, s35, v33
    v_lshlrev_b32 v28, 16, v34
    v_and_b32 v29, s35, v34
    v_lshlrev_b32 v30, 16, v35
    v_and_b32 v31, s35, v35
    v_sub_f32 v16, v16, v24
    v_sub_f32 v17, v17, v25
    v_sub_f32 v18, v18, v26
    v_sub_f32 v19, v19, v27
    v_sub_f32 v20, v20, v28
    v_sub_f32 v21, v21, v29
    v_sub_f32 v22, v22, v30
    v_sub_f32 v23, v23, v31
    v_cvt_pk_bf16_f32 v36, v16, v17
    v_cvt_pk_bf16_f32 v37, v18, v19
    v_cvt_pk_bf16_f32 v38, v20, v21
    v_cvt_pk_bf16_f32 v39, v22, v23
    s_add_u32 s23, s24, 0x1000
    buffer_store_dwordx4 v[32:35], v5, s[12:15], s24 offen sc0 sc1
    buffer_store_dwordx4 v[36:39], v5, s[12:15], s23 offen sc0 sc1

    s_branch k2_done
k2_cv_join:
    s_waitcnt vmcnt(0) lgkmcnt(0)
    s_barrier

    s_setprio 0
    s_mov_b32 s56, s56
    s_and_b32 s57, s57, 0xffff
    s_mov_b32 s58, 0x158000
    s_mov_b32 s59, 0x00020000

    s_lshl_b32 s36, s20, 12
    v_add_u32 v72, s36, v5
    buffer_load_dwordx4 v[68:71], v72, s[56:59], 0 offen

    ds_read_b128 v[80:83], v12 offset:0
    ds_read_b128 v[84:87], v13 offset:0
    ds_read_b128 v[88:91], v13 offset:512
    ds_read_b128 v[92:95], v13 offset:6144
    ds_read_b128 v[96:99], v13 offset:6656
    ds_read_b128 v[100:103], v12 offset:2048
    ds_read_b128 v[104:107], v12 offset:32
    ds_read_b128 v[108:111], v13 offset:3072
    ds_read_b128 v[112:115], v13 offset:3584
    ds_read_b128 v[116:119], v13 offset:9216
    ds_read_b128 v[120:123], v13 offset:9728
    ds_read_b128 v[124:127], v12 offset:2080
    s_waitcnt lgkmcnt(10)
    v_mfma_f32_32x32x16_bf16 v[16:31], v[80:83], v[84:87], 0
    s_waitcnt lgkmcnt(9)
    v_mfma_f32_32x32x16_bf16 v[48:63], v[80:83], v[88:91], 0
    s_waitcnt lgkmcnt(8)
    v_mfma_f32_32x32x16_bf16 v[16:31], v[80:83], v[92:95], v[16:31]
    s_waitcnt lgkmcnt(7)
    v_mfma_f32_32x32x16_bf16 v[48:63], v[80:83], v[96:99], v[48:63]
    s_waitcnt lgkmcnt(6)
    v_mfma_f32_32x32x16_bf16 v[16:31], v[100:103], v[88:91], v[16:31]
    v_mfma_f32_32x32x16_bf16 v[16:31], v[100:103], v[96:99], v[16:31]
    ds_read_b128 v[80:83], v12 offset:64
    ds_read_b128 v[84:87], v13 offset:16
    ds_read_b128 v[88:91], v13 offset:528
    ds_read_b128 v[92:95], v13 offset:6160
    ds_read_b128 v[96:99], v13 offset:6672
    ds_read_b128 v[100:103], v12 offset:2112
    s_waitcnt lgkmcnt(10)
    v_mfma_f32_32x32x16_bf16 v[16:31], v[104:107], v[108:111], v[16:31]
    s_waitcnt lgkmcnt(9)
    v_mfma_f32_32x32x16_bf16 v[48:63], v[104:107], v[112:115], v[48:63]
    s_waitcnt lgkmcnt(8)
    v_mfma_f32_32x32x16_bf16 v[16:31], v[104:107], v[116:119], v[16:31]
    s_waitcnt lgkmcnt(7)
    v_mfma_f32_32x32x16_bf16 v[48:63], v[104:107], v[120:123], v[48:63]
    s_waitcnt lgkmcnt(6)
    v_mfma_f32_32x32x16_bf16 v[16:31], v[124:127], v[112:115], v[16:31]
    v_mfma_f32_32x32x16_bf16 v[16:31], v[124:127], v[120:123], v[16:31]
    ds_read_b128 v[104:107], v12 offset:96
    ds_read_b128 v[108:111], v13 offset:3088
    ds_read_b128 v[112:115], v13 offset:3600
    ds_read_b128 v[116:119], v13 offset:9232
    ds_read_b128 v[120:123], v13 offset:9744
    ds_read_b128 v[124:127], v12 offset:2144
    s_waitcnt lgkmcnt(10)
    v_mfma_f32_32x32x16_bf16 v[16:31], v[80:83], v[84:87], v[16:31]
    s_waitcnt lgkmcnt(9)
    v_mfma_f32_32x32x16_bf16 v[48:63], v[80:83], v[88:91], v[48:63]
    s_waitcnt lgkmcnt(8)
    v_mfma_f32_32x32x16_bf16 v[16:31], v[80:83], v[92:95], v[16:31]
    s_waitcnt lgkmcnt(7)
    v_mfma_f32_32x32x16_bf16 v[48:63], v[80:83], v[96:99], v[48:63]
    s_waitcnt lgkmcnt(6)
    v_mfma_f32_32x32x16_bf16 v[16:31], v[100:103], v[88:91], v[16:31]
    v_mfma_f32_32x32x16_bf16 v[16:31], v[100:103], v[96:99], v[16:31]
    ds_read_b128 v[80:83], v12 offset:128
    ds_read_b128 v[84:87], v13 offset:32
    ds_read_b128 v[88:91], v13 offset:544
    ds_read_b128 v[92:95], v13 offset:6176
    ds_read_b128 v[96:99], v13 offset:6688
    ds_read_b128 v[100:103], v12 offset:2176
    s_waitcnt lgkmcnt(10)
    v_mfma_f32_32x32x16_bf16 v[16:31], v[104:107], v[108:111], v[16:31]
    s_waitcnt lgkmcnt(9)
    v_mfma_f32_32x32x16_bf16 v[48:63], v[104:107], v[112:115], v[48:63]
    s_waitcnt lgkmcnt(8)
    v_mfma_f32_32x32x16_bf16 v[16:31], v[104:107], v[116:119], v[16:31]
    s_waitcnt lgkmcnt(7)
    v_mfma_f32_32x32x16_bf16 v[48:63], v[104:107], v[120:123], v[48:63]
    s_waitcnt lgkmcnt(6)
    v_mfma_f32_32x32x16_bf16 v[16:31], v[124:127], v[112:115], v[16:31]
    v_mfma_f32_32x32x16_bf16 v[16:31], v[124:127], v[120:123], v[16:31]
    ds_read_b128 v[104:107], v12 offset:160
    ds_read_b128 v[108:111], v13 offset:3104
    ds_read_b128 v[112:115], v13 offset:3616
    ds_read_b128 v[116:119], v13 offset:9248
    ds_read_b128 v[120:123], v13 offset:9760
    ds_read_b128 v[124:127], v12 offset:2208
    s_waitcnt lgkmcnt(10)
    v_mfma_f32_32x32x16_bf16 v[16:31], v[80:83], v[84:87], v[16:31]
    s_waitcnt lgkmcnt(9)
    v_mfma_f32_32x32x16_bf16 v[48:63], v[80:83], v[88:91], v[48:63]
    s_waitcnt lgkmcnt(8)
    v_mfma_f32_32x32x16_bf16 v[16:31], v[80:83], v[92:95], v[16:31]
    s_waitcnt lgkmcnt(7)
    v_mfma_f32_32x32x16_bf16 v[48:63], v[80:83], v[96:99], v[48:63]
    s_waitcnt lgkmcnt(6)
    v_mfma_f32_32x32x16_bf16 v[16:31], v[100:103], v[88:91], v[16:31]
    v_mfma_f32_32x32x16_bf16 v[16:31], v[100:103], v[96:99], v[16:31]
    ds_read_b128 v[80:83], v12 offset:192
    ds_read_b128 v[84:87], v13 offset:48
    ds_read_b128 v[88:91], v13 offset:560
    ds_read_b128 v[92:95], v13 offset:6192
    ds_read_b128 v[96:99], v13 offset:6704
    ds_read_b128 v[100:103], v12 offset:2240
    s_waitcnt lgkmcnt(10)
    v_mfma_f32_32x32x16_bf16 v[16:31], v[104:107], v[108:111], v[16:31]
    s_waitcnt lgkmcnt(9)
    v_mfma_f32_32x32x16_bf16 v[48:63], v[104:107], v[112:115], v[48:63]
    s_waitcnt lgkmcnt(8)
    v_mfma_f32_32x32x16_bf16 v[16:31], v[104:107], v[116:119], v[16:31]
    s_waitcnt lgkmcnt(7)
    v_mfma_f32_32x32x16_bf16 v[48:63], v[104:107], v[120:123], v[48:63]
    s_waitcnt lgkmcnt(6)
    v_mfma_f32_32x32x16_bf16 v[16:31], v[124:127], v[112:115], v[16:31]
    v_mfma_f32_32x32x16_bf16 v[16:31], v[124:127], v[120:123], v[16:31]
    ds_read_b128 v[104:107], v12 offset:224
    ds_read_b128 v[108:111], v13 offset:3120
    ds_read_b128 v[112:115], v13 offset:3632
    ds_read_b128 v[116:119], v13 offset:9264
    ds_read_b128 v[120:123], v13 offset:9776
    ds_read_b128 v[124:127], v12 offset:2272
    s_waitcnt lgkmcnt(10)
    v_mfma_f32_32x32x16_bf16 v[16:31], v[80:83], v[84:87], v[16:31]
    s_waitcnt lgkmcnt(9)
    v_mfma_f32_32x32x16_bf16 v[48:63], v[80:83], v[88:91], v[48:63]
    s_waitcnt lgkmcnt(8)
    v_mfma_f32_32x32x16_bf16 v[16:31], v[80:83], v[92:95], v[16:31]
    s_waitcnt lgkmcnt(7)
    v_mfma_f32_32x32x16_bf16 v[48:63], v[80:83], v[96:99], v[48:63]
    s_waitcnt lgkmcnt(6)
    v_mfma_f32_32x32x16_bf16 v[16:31], v[100:103], v[88:91], v[16:31]
    v_mfma_f32_32x32x16_bf16 v[16:31], v[100:103], v[96:99], v[16:31]
    ds_read_b128 v[80:83], v12 offset:256
    ds_read_b128 v[84:87], v13 offset:64
    ds_read_b128 v[88:91], v13 offset:576
    ds_read_b128 v[92:95], v13 offset:6208
    ds_read_b128 v[96:99], v13 offset:6720
    ds_read_b128 v[100:103], v12 offset:2304
    s_waitcnt lgkmcnt(10)
    v_mfma_f32_32x32x16_bf16 v[16:31], v[104:107], v[108:111], v[16:31]
    s_waitcnt lgkmcnt(9)
    v_mfma_f32_32x32x16_bf16 v[48:63], v[104:107], v[112:115], v[48:63]
    s_waitcnt lgkmcnt(8)
    v_mfma_f32_32x32x16_bf16 v[16:31], v[104:107], v[116:119], v[16:31]
    s_waitcnt lgkmcnt(7)
    v_mfma_f32_32x32x16_bf16 v[48:63], v[104:107], v[120:123], v[48:63]
    s_waitcnt lgkmcnt(6)
    v_mfma_f32_32x32x16_bf16 v[16:31], v[124:127], v[112:115], v[16:31]
    v_mfma_f32_32x32x16_bf16 v[16:31], v[124:127], v[120:123], v[16:31]
    ds_read_b128 v[104:107], v12 offset:288
    ds_read_b128 v[108:111], v13 offset:3136
    ds_read_b128 v[112:115], v13 offset:3648
    ds_read_b128 v[116:119], v13 offset:9280
    ds_read_b128 v[120:123], v13 offset:9792
    ds_read_b128 v[124:127], v12 offset:2336
    s_waitcnt lgkmcnt(10)
    v_mfma_f32_32x32x16_bf16 v[16:31], v[80:83], v[84:87], v[16:31]
    s_waitcnt lgkmcnt(9)
    v_mfma_f32_32x32x16_bf16 v[48:63], v[80:83], v[88:91], v[48:63]
    s_waitcnt lgkmcnt(8)
    v_mfma_f32_32x32x16_bf16 v[16:31], v[80:83], v[92:95], v[16:31]
    s_waitcnt lgkmcnt(7)
    v_mfma_f32_32x32x16_bf16 v[48:63], v[80:83], v[96:99], v[48:63]
    s_waitcnt lgkmcnt(6)
    v_mfma_f32_32x32x16_bf16 v[16:31], v[100:103], v[88:91], v[16:31]
    v_mfma_f32_32x32x16_bf16 v[16:31], v[100:103], v[96:99], v[16:31]
    ds_read_b128 v[80:83], v12 offset:320
    ds_read_b128 v[84:87], v13 offset:80
    ds_read_b128 v[88:91], v13 offset:592
    ds_read_b128 v[92:95], v13 offset:6224
    ds_read_b128 v[96:99], v13 offset:6736
    ds_read_b128 v[100:103], v12 offset:2368
    s_waitcnt lgkmcnt(10)
    v_mfma_f32_32x32x16_bf16 v[16:31], v[104:107], v[108:111], v[16:31]
    s_waitcnt lgkmcnt(9)
    v_mfma_f32_32x32x16_bf16 v[48:63], v[104:107], v[112:115], v[48:63]
    s_waitcnt lgkmcnt(8)
    v_mfma_f32_32x32x16_bf16 v[16:31], v[104:107], v[116:119], v[16:31]
    s_waitcnt lgkmcnt(7)
    v_mfma_f32_32x32x16_bf16 v[48:63], v[104:107], v[120:123], v[48:63]
    s_waitcnt lgkmcnt(6)
    v_mfma_f32_32x32x16_bf16 v[16:31], v[124:127], v[112:115], v[16:31]
    v_mfma_f32_32x32x16_bf16 v[16:31], v[124:127], v[120:123], v[16:31]
    ds_read_b128 v[104:107], v12 offset:352
    ds_read_b128 v[108:111], v13 offset:3152
    ds_read_b128 v[112:115], v13 offset:3664
    ds_read_b128 v[116:119], v13 offset:9296
    ds_read_b128 v[120:123], v13 offset:9808
    ds_read_b128 v[124:127], v12 offset:2400
    s_waitcnt lgkmcnt(10)
    v_mfma_f32_32x32x16_bf16 v[16:31], v[80:83], v[84:87], v[16:31]
    s_waitcnt lgkmcnt(9)
    v_mfma_f32_32x32x16_bf16 v[48:63], v[80:83], v[88:91], v[48:63]
    s_waitcnt lgkmcnt(8)
    v_mfma_f32_32x32x16_bf16 v[16:31], v[80:83], v[92:95], v[16:31]
    s_waitcnt lgkmcnt(7)
    v_mfma_f32_32x32x16_bf16 v[48:63], v[80:83], v[96:99], v[48:63]
    s_waitcnt lgkmcnt(6)
    v_mfma_f32_32x32x16_bf16 v[16:31], v[100:103], v[88:91], v[16:31]
    v_mfma_f32_32x32x16_bf16 v[16:31], v[100:103], v[96:99], v[16:31]
    ds_read_b128 v[80:83], v12 offset:384
    ds_read_b128 v[84:87], v13 offset:96
    ds_read_b128 v[88:91], v13 offset:608
    ds_read_b128 v[92:95], v13 offset:6240
    ds_read_b128 v[96:99], v13 offset:6752
    ds_read_b128 v[100:103], v12 offset:2432
    s_waitcnt lgkmcnt(10)
    v_mfma_f32_32x32x16_bf16 v[16:31], v[104:107], v[108:111], v[16:31]
    s_waitcnt lgkmcnt(9)
    v_mfma_f32_32x32x16_bf16 v[48:63], v[104:107], v[112:115], v[48:63]
    s_waitcnt lgkmcnt(8)
    v_mfma_f32_32x32x16_bf16 v[16:31], v[104:107], v[116:119], v[16:31]
    s_waitcnt lgkmcnt(7)
    v_mfma_f32_32x32x16_bf16 v[48:63], v[104:107], v[120:123], v[48:63]
    s_waitcnt lgkmcnt(6)
    v_mfma_f32_32x32x16_bf16 v[16:31], v[124:127], v[112:115], v[16:31]
    v_mfma_f32_32x32x16_bf16 v[16:31], v[124:127], v[120:123], v[16:31]
    ds_read_b128 v[104:107], v12 offset:416
    ds_read_b128 v[108:111], v13 offset:3168
    ds_read_b128 v[112:115], v13 offset:3680
    ds_read_b128 v[116:119], v13 offset:9312
    ds_read_b128 v[120:123], v13 offset:9824
    ds_read_b128 v[124:127], v12 offset:2464
    s_waitcnt lgkmcnt(10)
    v_mfma_f32_32x32x16_bf16 v[16:31], v[80:83], v[84:87], v[16:31]
    s_waitcnt lgkmcnt(9)
    v_mfma_f32_32x32x16_bf16 v[48:63], v[80:83], v[88:91], v[48:63]
    s_waitcnt lgkmcnt(8)
    v_mfma_f32_32x32x16_bf16 v[16:31], v[80:83], v[92:95], v[16:31]
    s_waitcnt lgkmcnt(7)
    v_mfma_f32_32x32x16_bf16 v[48:63], v[80:83], v[96:99], v[48:63]
    s_waitcnt lgkmcnt(6)
    v_mfma_f32_32x32x16_bf16 v[16:31], v[100:103], v[88:91], v[16:31]
    v_mfma_f32_32x32x16_bf16 v[16:31], v[100:103], v[96:99], v[16:31]
    ds_read_b128 v[80:83], v12 offset:448
    ds_read_b128 v[84:87], v13 offset:112
    ds_read_b128 v[88:91], v13 offset:624
    ds_read_b128 v[92:95], v13 offset:6256
    ds_read_b128 v[96:99], v13 offset:6768
    ds_read_b128 v[100:103], v12 offset:2496
    s_waitcnt lgkmcnt(10)
    v_mfma_f32_32x32x16_bf16 v[16:31], v[104:107], v[108:111], v[16:31]
    s_waitcnt lgkmcnt(9)
    v_mfma_f32_32x32x16_bf16 v[48:63], v[104:107], v[112:115], v[48:63]
    s_waitcnt lgkmcnt(8)
    v_mfma_f32_32x32x16_bf16 v[16:31], v[104:107], v[116:119], v[16:31]
    s_waitcnt lgkmcnt(7)
    v_mfma_f32_32x32x16_bf16 v[48:63], v[104:107], v[120:123], v[48:63]
    s_waitcnt lgkmcnt(6)
    v_mfma_f32_32x32x16_bf16 v[16:31], v[124:127], v[112:115], v[16:31]
    v_mfma_f32_32x32x16_bf16 v[16:31], v[124:127], v[120:123], v[16:31]
    ds_read_b128 v[104:107], v12 offset:480
    ds_read_b128 v[108:111], v13 offset:3184
    ds_read_b128 v[112:115], v13 offset:3696
    ds_read_b128 v[116:119], v13 offset:9328
    ds_read_b128 v[120:123], v13 offset:9840
    ds_read_b128 v[124:127], v12 offset:2528
    s_waitcnt lgkmcnt(10)
    v_mfma_f32_32x32x16_bf16 v[16:31], v[80:83], v[84:87], v[16:31]
    s_waitcnt lgkmcnt(9)
    v_mfma_f32_32x32x16_bf16 v[48:63], v[80:83], v[88:91], v[48:63]
    s_waitcnt lgkmcnt(8)
    v_mfma_f32_32x32x16_bf16 v[16:31], v[80:83], v[92:95], v[16:31]
    s_waitcnt lgkmcnt(7)
    v_mfma_f32_32x32x16_bf16 v[48:63], v[80:83], v[96:99], v[48:63]
    s_waitcnt lgkmcnt(6)
    v_mfma_f32_32x32x16_bf16 v[16:31], v[100:103], v[88:91], v[16:31]
    v_mfma_f32_32x32x16_bf16 v[16:31], v[100:103], v[96:99], v[16:31]
    s_waitcnt lgkmcnt(4)
    v_mfma_f32_32x32x16_bf16 v[16:31], v[104:107], v[108:111], v[16:31]
    s_waitcnt lgkmcnt(3)
    v_mfma_f32_32x32x16_bf16 v[48:63], v[104:107], v[112:115], v[48:63]
    s_waitcnt lgkmcnt(2)
    v_mfma_f32_32x32x16_bf16 v[16:31], v[104:107], v[116:119], v[16:31]
    s_waitcnt lgkmcnt(1)
    v_mfma_f32_32x32x16_bf16 v[48:63], v[104:107], v[120:123], v[48:63]
    s_waitcnt lgkmcnt(0)
    v_mfma_f32_32x32x16_bf16 v[16:31], v[124:127], v[112:115], v[16:31]
    v_mfma_f32_32x32x16_bf16 v[16:31], v[124:127], v[120:123], v[16:31]
k2_cv_fin:
    s_setprio 2
    s_waitcnt lgkmcnt(0)
    s_nop 7
    s_nop 7

    s_barrier
    v_mul_u32_u24 v14, 144, v4
    v_lshl_add_u32 v14, v6, 4, v14
    s_mul_i32 s36, s3, 4608
    v_add_u32 v14, s36, v14

    ds_write_b128 v14, v[16:19] offset:0
    ds_write_b128 v14, v[20:23] offset:32
    ds_write_b128 v14, v[24:27] offset:64
    ds_write_b128 v14, v[28:31] offset:96
    ds_write_b128 v14, v[48:51] offset:18432
    ds_write_b128 v14, v[52:55] offset:18464
    ds_write_b128 v14, v[56:59] offset:18496
    ds_write_b128 v14, v[60:63] offset:18528
    v_lshrrev_b32 v14, 2, v0
    v_and_b32 v14, 31, v14
    v_mul_u32_u24 v14, 144, v14
    v_and_b32 v15, 3, v0
    v_lshl_add_u32 v14, v15, 5, v14
    s_cmp_lt_u32 s3, 2
    s_cselect_b32 s36, 18432, 0
    v_add_u32 v14, s36, v14
    s_waitcnt lgkmcnt(0)
    s_barrier

    ds_read_b128 v[16:19], v14 offset:0
    ds_read_b128 v[20:23], v14 offset:16
    ds_read_b128 v[24:27], v14 offset:4608
    ds_read_b128 v[28:31], v14 offset:4624
    ds_read_b128 v[32:35], v14 offset:9216
    ds_read_b128 v[36:39], v14 offset:9232
    ds_read_b128 v[40:43], v14 offset:13824
    ds_read_b128 v[44:47], v14 offset:13840
    s_waitcnt lgkmcnt(0)
    v_add_f32 v16, v16, v40
    v_add_f32 v17, v17, v41
    v_add_f32 v18, v18, v42
    v_add_f32 v19, v19, v43
    v_add_f32 v20, v20, v44
    v_add_f32 v21, v21, v45
    v_add_f32 v22, v22, v46
    v_add_f32 v23, v23, v47
    s_waitcnt lgkmcnt(0)
    s_and_b32 s21, s20, 1
    s_lshl_b32 s21, s21, 4
    s_lshr_b32 s22, s22, s21
    s_lshl_b32 s22, s22, 16
    s_mov_b32 s23, 0xffff0000
    s_lshl_b32 s24, s20, 12

    v_add_f32 v24, v24, v32
    v_add_f32 v25, v25, v33
    v_add_f32 v26, v26, v34
    v_add_f32 v27, v27, v35
    v_add_f32 v28, v28, v36
    v_add_f32 v29, v29, v37
    v_add_f32 v30, v30, v38
    v_add_f32 v31, v31, v39
    v_add_f32 v16, v16, v24
    v_add_f32 v17, v17, v25
    v_add_f32 v18, v18, v26
    v_add_f32 v19, v19, v27
    v_add_f32 v20, v20, v28
    v_add_f32 v21, v21, v29
    v_add_f32 v22, v22, v30
    v_add_f32 v23, v23, v31
    v_cvt_pk_bf16_f32 v24, v16, v17
    v_lshlrev_b32 v25, 16, v8
    v_and_b32 v26, s23, v8
    v_mul_f32 v25, s22, v25
    v_mul_f32 v26, s22, v26
    v_cvt_pk_bf16_f32 v27, v25, v26
    v_lshlrev_b32 v25, 16, v24
    v_and_b32 v26, s23, v24
    v_lshlrev_b32 v28, 16, v27
    v_and_b32 v29, s23, v27
    v_add_f32 v25, v25, v28
    v_add_f32 v26, v26, v29
    v_cvt_pk_bf16_f32 v32, v25, v26

    v_cvt_pk_bf16_f32 v24, v18, v19
    v_lshlrev_b32 v25, 16, v9
    v_and_b32 v26, s23, v9
    v_mul_f32 v25, s22, v25
    v_mul_f32 v26, s22, v26
    v_cvt_pk_bf16_f32 v27, v25, v26
    v_lshlrev_b32 v25, 16, v24
    v_and_b32 v26, s23, v24
    v_lshlrev_b32 v28, 16, v27
    v_and_b32 v29, s23, v27
    v_add_f32 v25, v25, v28
    v_add_f32 v26, v26, v29
    v_cvt_pk_bf16_f32 v33, v25, v26

    v_cvt_pk_bf16_f32 v24, v20, v21
    v_lshlrev_b32 v25, 16, v10
    v_and_b32 v26, s23, v10
    v_mul_f32 v25, s22, v25
    v_mul_f32 v26, s22, v26
    v_cvt_pk_bf16_f32 v27, v25, v26
    v_lshlrev_b32 v25, 16, v24
    v_and_b32 v26, s23, v24
    v_lshlrev_b32 v28, 16, v27
    v_and_b32 v29, s23, v27
    v_add_f32 v25, v25, v28
    v_add_f32 v26, v26, v29
    v_cvt_pk_bf16_f32 v34, v25, v26

    v_cvt_pk_bf16_f32 v24, v22, v23
    v_lshlrev_b32 v25, 16, v11
    v_and_b32 v26, s23, v11
    v_mul_f32 v25, s22, v25
    v_mul_f32 v26, s22, v26
    v_cvt_pk_bf16_f32 v27, v25, v26
    v_lshlrev_b32 v25, 16, v24
    v_and_b32 v26, s23, v24
    v_lshlrev_b32 v28, 16, v27
    v_and_b32 v29, s23, v27
    v_add_f32 v25, v25, v28
    v_add_f32 v26, v26, v29
    v_cvt_pk_bf16_f32 v35, v25, v26

    buffer_store_dwordx4 v[32:35], v5, s[16:19], s24 offen sc0 sc1

    s_branch k2_done
k2_gemm:
    s_load_dwordx2 s[4:5], s[0:1], 80
    s_and_b32 s20, s2, 15
    s_sub_u32 s21, s2, 0
    s_lshr_b32 s21, s21, 4
    s_waitcnt lgkmcnt(0)

    s_setprio 0
    s_mov_b32 s8, s6
    s_and_b32 s9, s7, 0xffff
    s_mov_b32 s10, 0x200000
    s_mov_b32 s11, 0x00020000

    s_mov_b32 s12, s4
    s_and_b32 s13, s5, 0xffff
    s_mov_b32 s14, 0x158000
    s_mov_b32 s15, 0x00020000

    s_add_u32 s16, s6, 0xc20000
    s_addc_u32 s17, s7, 0
    s_and_b32 s17, s17, 0xffff
    s_mov_b32 s18, 0x580000
    s_mov_b32 s19, 0x00020000

    s_lshl_b32 s22, s3, 15
    v_lshl_add_u32 v3, v2, 4, s22
    s_mul_i32 s22, s3, 96
    v_add_u32 v4, s22, v2
    v_add_u32 v5, 64, v4
    s_movk_i32 s23, 5462
    s_movk_i32 s24, 2752
    v_mul_u32_u24 v6, s23, v4
    v_lshrrev_b32 v6, 16, v6
    v_mul_u32_u24 v7, 12, v6
    v_sub_u32 v4, v4, v7
    v_lshlrev_b32 v4, 4, v4
    v_mad_u32_u24 v4, v6, s24, v4
    v_mul_u32_u24 v6, s23, v5
    v_lshrrev_b32 v6, 16, v6
    v_mul_u32_u24 v7, 12, v6
    v_sub_u32 v5, v5, v7
    v_lshlrev_b32 v5, 4, v5
    v_mad_u32_u24 v5, v6, s24, v5
    s_lshl_b32 s25, s20, 17
    s_mul_i32 s26, s21, 192
    s_lshr_b32 s36, s20, 3
    s_lshl_b32 s36, s36, 3
    s_add_u32 s36, s36, s21
    s_and_b32 s36, s36, 0
    s_mul_i32 s28, s3, 1536
    s_mov_b64 s[30:31], -1
    s_mov_b32 s32, -1
    s_mov_b32 s33, 0

    v_and_b32 v6, 31, v2
    v_lshrrev_b32 v7, 5, v2
    s_lshl_b32 s22, s3, 5
    v_add_u32 v8, s22, v6
    v_lshlrev_b32 v8, 6, v8
    v_lshrrev_b32 v9, 2, v6
    v_and_b32 v9, 3, v9
    v_xor_b32 v10, v9, v7
    v_lshl_add_u32 v10, v10, 4, v8
    v_xor_b32 v11, 2, v9
    v_xor_b32 v11, v11, v7
    v_lshl_add_u32 v11, v11, 4, v8
    v_lshlrev_b32 v12, 3, v7
    v_bfe_u32 v13, v2, 2, 2
    v_add_u32 v12, v12, v13
    v_mul_u32_u24 v12, 192, v12
    v_bfe_u32 v13, v2, 4, 1
    v_lshl_add_u32 v12, v13, 5, v12
    v_and_b32 v13, 3, v2
    v_lshl_add_u32 v12, v13, 3, v12

    v_mov_b32 v16, 0
    v_mov_b32 v17, 0
    v_mov_b32 v18, 0
    v_mov_b32 v19, 0
    v_mov_b32 v20, 0
    v_mov_b32 v21, 0
    v_mov_b32 v22, 0
    v_mov_b32 v23, 0
    v_mov_b32 v24, 0
    v_mov_b32 v25, 0
    v_mov_b32 v26, 0
    v_mov_b32 v27, 0
    v_mov_b32 v28, 0
    v_mov_b32 v29, 0
    v_mov_b32 v30, 0
    v_mov_b32 v31, 0
    v_mov_b32 v32, 0
    v_mov_b32 v33, 0
    v_mov_b32 v34, 0
    v_mov_b32 v35, 0
    v_mov_b32 v36, 0
    v_mov_b32 v37, 0
    v_mov_b32 v38, 0
    v_mov_b32 v39, 0
    v_mov_b32 v40, 0
    v_mov_b32 v41, 0
    v_mov_b32 v42, 0
    v_mov_b32 v43, 0
    v_mov_b32 v44, 0
    v_mov_b32 v45, 0
    v_mov_b32 v46, 0
    v_mov_b32 v47, 0
    v_mov_b32 v48, 0
    v_mov_b32 v49, 0
    v_mov_b32 v50, 0
    v_mov_b32 v51, 0
    v_mov_b32 v52, 0
    v_mov_b32 v53, 0
    v_mov_b32 v54, 0
    v_mov_b32 v55, 0
    v_mov_b32 v56, 0
    v_mov_b32 v57, 0
    v_mov_b32 v58, 0
    v_mov_b32 v59, 0
    v_mov_b32 v60, 0
    v_mov_b32 v61, 0
    v_mov_b32 v62, 0
    v_mov_b32 v63, 0
    s_lshl_b32 s37, s36, 11
    s_add_u32 s37, s37, s25
    s_mul_i32 s38, s36, 88064
    buffer_load_dwordx4 v[112:115], v3, s[8:11], s37 offen
    buffer_load_dwordx4 v[116:119], v3, s[8:11], s37 offen offset:1024
    s_add_u32 m0, s28, 0
    s_add_u32 s38, s38, s26
    buffer_load_dwordx4 v4, s[12:15], s38 offen lds
    s_add_u32 m0, s28, 1024
    s_mov_b64 exec, s[32:33]
    buffer_load_dwordx4 v5, s[12:15], s38 offen lds
    s_mov_b64 exec, s[30:31]
    s_add_u32 s36, s36, 1
    s_and_b32 s36, s36, 15

    s_lshl_b32 s37, s36, 11
    s_add_u32 s37, s37, s25
    s_mul_i32 s38, s36, 88064
    buffer_load_dwordx4 v[120:123], v3, s[8:11], s37 offen
    buffer_load_dwordx4 v[124:127], v3, s[8:11], s37 offen offset:1024
    s_add_u32 m0, s28, 6144
    s_add_u32 s38, s38, s26
    buffer_load_dwordx4 v4, s[12:15], s38 offen lds
    s_add_u32 m0, s28, 7168
    s_mov_b64 exec, s[32:33]
    buffer_load_dwordx4 v5, s[12:15], s38 offen lds
    s_mov_b64 exec, s[30:31]
    s_add_u32 s36, s36, 1
    s_and_b32 s36, s36, 15

    s_lshl_b32 s37, s36, 11
    s_add_u32 s37, s37, s25
    s_mul_i32 s38, s36, 88064
    buffer_load_dwordx4 v[128:131], v3, s[8:11], s37 offen
    buffer_load_dwordx4 v[132:135], v3, s[8:11], s37 offen offset:1024
    s_add_u32 m0, s28, 12288
    s_add_u32 s38, s38, s26
    buffer_load_dwordx4 v4, s[12:15], s38 offen lds
    s_add_u32 m0, s28, 13312
    s_mov_b64 exec, s[32:33]
    buffer_load_dwordx4 v5, s[12:15], s38 offen lds
    s_mov_b64 exec, s[30:31]
    s_add_u32 s36, s36, 1
    s_and_b32 s36, s36, 15

    s_waitcnt vmcnt(8)
    s_barrier
    ds_read_b64_tr_b16 v[64:65], v12 offset:0
    ds_read_b64_tr_b16 v[66:67], v12 offset:768
    ds_read_b64_tr_b16 v[68:69], v12 offset:64
    ds_read_b64_tr_b16 v[70:71], v12 offset:832
    ds_read_b64_tr_b16 v[72:73], v12 offset:128
    ds_read_b64_tr_b16 v[74:75], v12 offset:896
    ds_read_b64_tr_b16 v[76:77], v12 offset:3072
    ds_read_b64_tr_b16 v[78:79], v12 offset:3840
    ds_read_b64_tr_b16 v[80:81], v12 offset:3136
    ds_read_b64_tr_b16 v[82:83], v12 offset:3904
    ds_read_b64_tr_b16 v[84:85], v12 offset:3200
    ds_read_b64_tr_b16 v[86:87], v12 offset:3968
    s_waitcnt vmcnt(4) lgkmcnt(0)
    s_barrier
    s_lshl_b32 s37, s36, 11
    s_add_u32 s37, s37, s25
    s_mul_i32 s38, s36, 88064
    buffer_load_dwordx4 v[136:139], v3, s[8:11], s37 offen
    buffer_load_dwordx4 v[140:143], v3, s[8:11], s37 offen offset:1024
    s_add_u32 m0, s28, 0
    s_add_u32 s38, s38, s26
    buffer_load_dwordx4 v4, s[12:15], s38 offen lds
    s_add_u32 m0, s28, 1024
    s_mov_b64 exec, s[32:33]
    buffer_load_dwordx4 v5, s[12:15], s38 offen lds
    s_mov_b64 exec, s[30:31]
    s_add_u32 s36, s36, 1
    s_and_b32 s36, s36, 15

    ds_read_b64_tr_b16 v[88:89], v12 offset:6144
    ds_read_b64_tr_b16 v[90:91], v12 offset:6912
    ds_read_b64_tr_b16 v[92:93], v12 offset:6208
    ds_read_b64_tr_b16 v[94:95], v12 offset:6976
    ds_read_b64_tr_b16 v[96:97], v12 offset:6272
    ds_read_b64_tr_b16 v[98:99], v12 offset:7040
    ds_read_b64_tr_b16 v[100:101], v12 offset:9216
    ds_read_b64_tr_b16 v[102:103], v12 offset:9984
    ds_read_b64_tr_b16 v[104:105], v12 offset:9280
    ds_read_b64_tr_b16 v[106:107], v12 offset:10048
    ds_read_b64_tr_b16 v[108:109], v12 offset:9344
    ds_read_b64_tr_b16 v[110:111], v12 offset:10112
    v_mfma_f32_32x32x16_bf16 v[16:31], v[64:67], v[112:115], v[16:31]
    v_mfma_f32_32x32x16_bf16 v[32:47], v[68:71], v[112:115], v[32:47]
    v_mfma_f32_32x32x16_bf16 v[48:63], v[72:75], v[112:115], v[48:63]
    v_mfma_f32_32x32x16_bf16 v[16:31], v[76:79], v[116:119], v[16:31]
    v_mfma_f32_32x32x16_bf16 v[32:47], v[80:83], v[116:119], v[32:47]
    v_mfma_f32_32x32x16_bf16 v[48:63], v[84:87], v[116:119], v[48:63]
    s_waitcnt vmcnt(4) lgkmcnt(0)
    s_barrier
    s_lshl_b32 s37, s36, 11
    s_add_u32 s37, s37, s25
    s_mul_i32 s38, s36, 88064
    buffer_load_dwordx4 v[112:115], v3, s[8:11], s37 offen
    buffer_load_dwordx4 v[116:119], v3, s[8:11], s37 offen offset:1024
    s_add_u32 m0, s28, 6144
    s_add_u32 s38, s38, s26
    buffer_load_dwordx4 v4, s[12:15], s38 offen lds
    s_add_u32 m0, s28, 7168
    s_mov_b64 exec, s[32:33]
    buffer_load_dwordx4 v5, s[12:15], s38 offen lds
    s_mov_b64 exec, s[30:31]
    s_add_u32 s36, s36, 1
    s_and_b32 s36, s36, 15

    ds_read_b64_tr_b16 v[64:65], v12 offset:12288
    ds_read_b64_tr_b16 v[66:67], v12 offset:13056
    ds_read_b64_tr_b16 v[68:69], v12 offset:12352
    ds_read_b64_tr_b16 v[70:71], v12 offset:13120
    ds_read_b64_tr_b16 v[72:73], v12 offset:12416
    ds_read_b64_tr_b16 v[74:75], v12 offset:13184
    ds_read_b64_tr_b16 v[76:77], v12 offset:15360
    ds_read_b64_tr_b16 v[78:79], v12 offset:16128
    ds_read_b64_tr_b16 v[80:81], v12 offset:15424
    ds_read_b64_tr_b16 v[82:83], v12 offset:16192
    ds_read_b64_tr_b16 v[84:85], v12 offset:15488
    ds_read_b64_tr_b16 v[86:87], v12 offset:16256
    v_mfma_f32_32x32x16_bf16 v[16:31], v[88:91], v[120:123], v[16:31]
    v_mfma_f32_32x32x16_bf16 v[32:47], v[92:95], v[120:123], v[32:47]
    v_mfma_f32_32x32x16_bf16 v[48:63], v[96:99], v[120:123], v[48:63]
    v_mfma_f32_32x32x16_bf16 v[16:31], v[100:103], v[124:127], v[16:31]
    v_mfma_f32_32x32x16_bf16 v[32:47], v[104:107], v[124:127], v[32:47]
    v_mfma_f32_32x32x16_bf16 v[48:63], v[108:111], v[124:127], v[48:63]
    s_waitcnt vmcnt(4) lgkmcnt(0)
    s_barrier
    s_lshl_b32 s37, s36, 11
    s_add_u32 s37, s37, s25
    s_mul_i32 s38, s36, 88064
    buffer_load_dwordx4 v[120:123], v3, s[8:11], s37 offen
    buffer_load_dwordx4 v[124:127], v3, s[8:11], s37 offen offset:1024
    s_add_u32 m0, s28, 12288
    s_add_u32 s38, s38, s26
    buffer_load_dwordx4 v4, s[12:15], s38 offen lds
    s_add_u32 m0, s28, 13312
    s_mov_b64 exec, s[32:33]
    buffer_load_dwordx4 v5, s[12:15], s38 offen lds
    s_mov_b64 exec, s[30:31]
    s_add_u32 s36, s36, 1
    s_and_b32 s36, s36, 15

    ds_read_b64_tr_b16 v[88:89], v12 offset:0
    ds_read_b64_tr_b16 v[90:91], v12 offset:768
    ds_read_b64_tr_b16 v[92:93], v12 offset:64
    ds_read_b64_tr_b16 v[94:95], v12 offset:832
    ds_read_b64_tr_b16 v[96:97], v12 offset:128
    ds_read_b64_tr_b16 v[98:99], v12 offset:896
    ds_read_b64_tr_b16 v[100:101], v12 offset:3072
    ds_read_b64_tr_b16 v[102:103], v12 offset:3840
    ds_read_b64_tr_b16 v[104:105], v12 offset:3136
    ds_read_b64_tr_b16 v[106:107], v12 offset:3904
    ds_read_b64_tr_b16 v[108:109], v12 offset:3200
    ds_read_b64_tr_b16 v[110:111], v12 offset:3968
    v_mfma_f32_32x32x16_bf16 v[16:31], v[64:67], v[128:131], v[16:31]
    v_mfma_f32_32x32x16_bf16 v[32:47], v[68:71], v[128:131], v[32:47]
    v_mfma_f32_32x32x16_bf16 v[48:63], v[72:75], v[128:131], v[48:63]
    v_mfma_f32_32x32x16_bf16 v[16:31], v[76:79], v[132:135], v[16:31]
    v_mfma_f32_32x32x16_bf16 v[32:47], v[80:83], v[132:135], v[32:47]
    v_mfma_f32_32x32x16_bf16 v[48:63], v[84:87], v[132:135], v[48:63]
    s_waitcnt vmcnt(4) lgkmcnt(0)
    s_barrier
    s_lshl_b32 s37, s36, 11
    s_add_u32 s37, s37, s25
    s_mul_i32 s38, s36, 88064
    buffer_load_dwordx4 v[128:131], v3, s[8:11], s37 offen
    buffer_load_dwordx4 v[132:135], v3, s[8:11], s37 offen offset:1024
    s_add_u32 m0, s28, 0
    s_add_u32 s38, s38, s26
    buffer_load_dwordx4 v4, s[12:15], s38 offen lds
    s_add_u32 m0, s28, 1024
    s_mov_b64 exec, s[32:33]
    buffer_load_dwordx4 v5, s[12:15], s38 offen lds
    s_mov_b64 exec, s[30:31]
    s_add_u32 s36, s36, 1
    s_and_b32 s36, s36, 15

    ds_read_b64_tr_b16 v[64:65], v12 offset:6144
    ds_read_b64_tr_b16 v[66:67], v12 offset:6912
    ds_read_b64_tr_b16 v[68:69], v12 offset:6208
    ds_read_b64_tr_b16 v[70:71], v12 offset:6976
    ds_read_b64_tr_b16 v[72:73], v12 offset:6272
    ds_read_b64_tr_b16 v[74:75], v12 offset:7040
    ds_read_b64_tr_b16 v[76:77], v12 offset:9216
    ds_read_b64_tr_b16 v[78:79], v12 offset:9984
    ds_read_b64_tr_b16 v[80:81], v12 offset:9280
    ds_read_b64_tr_b16 v[82:83], v12 offset:10048
    ds_read_b64_tr_b16 v[84:85], v12 offset:9344
    ds_read_b64_tr_b16 v[86:87], v12 offset:10112
    v_mfma_f32_32x32x16_bf16 v[16:31], v[88:91], v[136:139], v[16:31]
    v_mfma_f32_32x32x16_bf16 v[32:47], v[92:95], v[136:139], v[32:47]
    v_mfma_f32_32x32x16_bf16 v[48:63], v[96:99], v[136:139], v[48:63]
    v_mfma_f32_32x32x16_bf16 v[16:31], v[100:103], v[140:143], v[16:31]
    v_mfma_f32_32x32x16_bf16 v[32:47], v[104:107], v[140:143], v[32:47]
    v_mfma_f32_32x32x16_bf16 v[48:63], v[108:111], v[140:143], v[48:63]
    s_waitcnt vmcnt(4) lgkmcnt(0)
    s_barrier
    s_lshl_b32 s37, s36, 11
    s_add_u32 s37, s37, s25
    s_mul_i32 s38, s36, 88064
    buffer_load_dwordx4 v[136:139], v3, s[8:11], s37 offen
    buffer_load_dwordx4 v[140:143], v3, s[8:11], s37 offen offset:1024
    s_add_u32 m0, s28, 6144
    s_add_u32 s38, s38, s26
    buffer_load_dwordx4 v4, s[12:15], s38 offen lds
    s_add_u32 m0, s28, 7168
    s_mov_b64 exec, s[32:33]
    buffer_load_dwordx4 v5, s[12:15], s38 offen lds
    s_mov_b64 exec, s[30:31]
    s_add_u32 s36, s36, 1
    s_and_b32 s36, s36, 15

    ds_read_b64_tr_b16 v[88:89], v12 offset:12288
    ds_read_b64_tr_b16 v[90:91], v12 offset:13056
    ds_read_b64_tr_b16 v[92:93], v12 offset:12352
    ds_read_b64_tr_b16 v[94:95], v12 offset:13120
    ds_read_b64_tr_b16 v[96:97], v12 offset:12416
    ds_read_b64_tr_b16 v[98:99], v12 offset:13184
    ds_read_b64_tr_b16 v[100:101], v12 offset:15360
    ds_read_b64_tr_b16 v[102:103], v12 offset:16128
    ds_read_b64_tr_b16 v[104:105], v12 offset:15424
    ds_read_b64_tr_b16 v[106:107], v12 offset:16192
    ds_read_b64_tr_b16 v[108:109], v12 offset:15488
    ds_read_b64_tr_b16 v[110:111], v12 offset:16256
    v_mfma_f32_32x32x16_bf16 v[16:31], v[64:67], v[112:115], v[16:31]
    v_mfma_f32_32x32x16_bf16 v[32:47], v[68:71], v[112:115], v[32:47]
    v_mfma_f32_32x32x16_bf16 v[48:63], v[72:75], v[112:115], v[48:63]
    v_mfma_f32_32x32x16_bf16 v[16:31], v[76:79], v[116:119], v[16:31]
    v_mfma_f32_32x32x16_bf16 v[32:47], v[80:83], v[116:119], v[32:47]
    v_mfma_f32_32x32x16_bf16 v[48:63], v[84:87], v[116:119], v[48:63]
    s_waitcnt vmcnt(4) lgkmcnt(0)
    s_barrier
    s_lshl_b32 s37, s36, 11
    s_add_u32 s37, s37, s25
    s_mul_i32 s38, s36, 88064
    buffer_load_dwordx4 v[112:115], v3, s[8:11], s37 offen
    buffer_load_dwordx4 v[116:119], v3, s[8:11], s37 offen offset:1024
    s_add_u32 m0, s28, 12288
    s_add_u32 s38, s38, s26
    buffer_load_dwordx4 v4, s[12:15], s38 offen lds
    s_add_u32 m0, s28, 13312
    s_mov_b64 exec, s[32:33]
    buffer_load_dwordx4 v5, s[12:15], s38 offen lds
    s_mov_b64 exec, s[30:31]
    s_add_u32 s36, s36, 1
    s_and_b32 s36, s36, 15

    ds_read_b64_tr_b16 v[64:65], v12 offset:0
    ds_read_b64_tr_b16 v[66:67], v12 offset:768
    ds_read_b64_tr_b16 v[68:69], v12 offset:64
    ds_read_b64_tr_b16 v[70:71], v12 offset:832
    ds_read_b64_tr_b16 v[72:73], v12 offset:128
    ds_read_b64_tr_b16 v[74:75], v12 offset:896
    ds_read_b64_tr_b16 v[76:77], v12 offset:3072
    ds_read_b64_tr_b16 v[78:79], v12 offset:3840
    ds_read_b64_tr_b16 v[80:81], v12 offset:3136
    ds_read_b64_tr_b16 v[82:83], v12 offset:3904
    ds_read_b64_tr_b16 v[84:85], v12 offset:3200
    ds_read_b64_tr_b16 v[86:87], v12 offset:3968
    v_mfma_f32_32x32x16_bf16 v[16:31], v[88:91], v[120:123], v[16:31]
    v_mfma_f32_32x32x16_bf16 v[32:47], v[92:95], v[120:123], v[32:47]
    v_mfma_f32_32x32x16_bf16 v[48:63], v[96:99], v[120:123], v[48:63]
    v_mfma_f32_32x32x16_bf16 v[16:31], v[100:103], v[124:127], v[16:31]
    v_mfma_f32_32x32x16_bf16 v[32:47], v[104:107], v[124:127], v[32:47]
    v_mfma_f32_32x32x16_bf16 v[48:63], v[108:111], v[124:127], v[48:63]
    s_waitcnt vmcnt(4) lgkmcnt(0)
    s_barrier
    s_lshl_b32 s37, s36, 11
    s_add_u32 s37, s37, s25
    s_mul_i32 s38, s36, 88064
    buffer_load_dwordx4 v[120:123], v3, s[8:11], s37 offen
    buffer_load_dwordx4 v[124:127], v3, s[8:11], s37 offen offset:1024
    s_add_u32 m0, s28, 0
    s_add_u32 s38, s38, s26
    buffer_load_dwordx4 v4, s[12:15], s38 offen lds
    s_add_u32 m0, s28, 1024
    s_mov_b64 exec, s[32:33]
    buffer_load_dwordx4 v5, s[12:15], s38 offen lds
    s_mov_b64 exec, s[30:31]
    s_add_u32 s36, s36, 1
    s_and_b32 s36, s36, 15

    ds_read_b64_tr_b16 v[88:89], v12 offset:6144
    ds_read_b64_tr_b16 v[90:91], v12 offset:6912
    ds_read_b64_tr_b16 v[92:93], v12 offset:6208
    ds_read_b64_tr_b16 v[94:95], v12 offset:6976
    ds_read_b64_tr_b16 v[96:97], v12 offset:6272
    ds_read_b64_tr_b16 v[98:99], v12 offset:7040
    ds_read_b64_tr_b16 v[100:101], v12 offset:9216
    ds_read_b64_tr_b16 v[102:103], v12 offset:9984
    ds_read_b64_tr_b16 v[104:105], v12 offset:9280
    ds_read_b64_tr_b16 v[106:107], v12 offset:10048
    ds_read_b64_tr_b16 v[108:109], v12 offset:9344
    ds_read_b64_tr_b16 v[110:111], v12 offset:10112
    v_mfma_f32_32x32x16_bf16 v[16:31], v[64:67], v[128:131], v[16:31]
    v_mfma_f32_32x32x16_bf16 v[32:47], v[68:71], v[128:131], v[32:47]
    v_mfma_f32_32x32x16_bf16 v[48:63], v[72:75], v[128:131], v[48:63]
    v_mfma_f32_32x32x16_bf16 v[16:31], v[76:79], v[132:135], v[16:31]
    v_mfma_f32_32x32x16_bf16 v[32:47], v[80:83], v[132:135], v[32:47]
    v_mfma_f32_32x32x16_bf16 v[48:63], v[84:87], v[132:135], v[48:63]
    s_waitcnt vmcnt(4) lgkmcnt(0)
    s_barrier
    s_lshl_b32 s37, s36, 11
    s_add_u32 s37, s37, s25
    s_mul_i32 s38, s36, 88064
    buffer_load_dwordx4 v[128:131], v3, s[8:11], s37 offen
    buffer_load_dwordx4 v[132:135], v3, s[8:11], s37 offen offset:1024
    s_add_u32 m0, s28, 6144
    s_add_u32 s38, s38, s26
    buffer_load_dwordx4 v4, s[12:15], s38 offen lds
    s_add_u32 m0, s28, 7168
    s_mov_b64 exec, s[32:33]
    buffer_load_dwordx4 v5, s[12:15], s38 offen lds
    s_mov_b64 exec, s[30:31]
    s_add_u32 s36, s36, 1
    s_and_b32 s36, s36, 15

    ds_read_b64_tr_b16 v[64:65], v12 offset:12288
    ds_read_b64_tr_b16 v[66:67], v12 offset:13056
    ds_read_b64_tr_b16 v[68:69], v12 offset:12352
    ds_read_b64_tr_b16 v[70:71], v12 offset:13120
    ds_read_b64_tr_b16 v[72:73], v12 offset:12416
    ds_read_b64_tr_b16 v[74:75], v12 offset:13184
    ds_read_b64_tr_b16 v[76:77], v12 offset:15360
    ds_read_b64_tr_b16 v[78:79], v12 offset:16128
    ds_read_b64_tr_b16 v[80:81], v12 offset:15424
    ds_read_b64_tr_b16 v[82:83], v12 offset:16192
    ds_read_b64_tr_b16 v[84:85], v12 offset:15488
    ds_read_b64_tr_b16 v[86:87], v12 offset:16256
    v_mfma_f32_32x32x16_bf16 v[16:31], v[88:91], v[136:139], v[16:31]
    v_mfma_f32_32x32x16_bf16 v[32:47], v[92:95], v[136:139], v[32:47]
    v_mfma_f32_32x32x16_bf16 v[48:63], v[96:99], v[136:139], v[48:63]
    v_mfma_f32_32x32x16_bf16 v[16:31], v[100:103], v[140:143], v[16:31]
    v_mfma_f32_32x32x16_bf16 v[32:47], v[104:107], v[140:143], v[32:47]
    v_mfma_f32_32x32x16_bf16 v[48:63], v[108:111], v[140:143], v[48:63]
    s_waitcnt vmcnt(4) lgkmcnt(0)
    s_barrier
    s_lshl_b32 s37, s36, 11
    s_add_u32 s37, s37, s25
    s_mul_i32 s38, s36, 88064
    buffer_load_dwordx4 v[136:139], v3, s[8:11], s37 offen
    buffer_load_dwordx4 v[140:143], v3, s[8:11], s37 offen offset:1024
    s_add_u32 m0, s28, 12288
    s_add_u32 s38, s38, s26
    buffer_load_dwordx4 v4, s[12:15], s38 offen lds
    s_add_u32 m0, s28, 13312
    s_mov_b64 exec, s[32:33]
    buffer_load_dwordx4 v5, s[12:15], s38 offen lds
    s_mov_b64 exec, s[30:31]
    s_add_u32 s36, s36, 1
    s_and_b32 s36, s36, 15

    ds_read_b64_tr_b16 v[88:89], v12 offset:0
    ds_read_b64_tr_b16 v[90:91], v12 offset:768
    ds_read_b64_tr_b16 v[92:93], v12 offset:64
    ds_read_b64_tr_b16 v[94:95], v12 offset:832
    ds_read_b64_tr_b16 v[96:97], v12 offset:128
    ds_read_b64_tr_b16 v[98:99], v12 offset:896
    ds_read_b64_tr_b16 v[100:101], v12 offset:3072
    ds_read_b64_tr_b16 v[102:103], v12 offset:3840
    ds_read_b64_tr_b16 v[104:105], v12 offset:3136
    ds_read_b64_tr_b16 v[106:107], v12 offset:3904
    ds_read_b64_tr_b16 v[108:109], v12 offset:3200
    ds_read_b64_tr_b16 v[110:111], v12 offset:3968
    v_mfma_f32_32x32x16_bf16 v[16:31], v[64:67], v[112:115], v[16:31]
    v_mfma_f32_32x32x16_bf16 v[32:47], v[68:71], v[112:115], v[32:47]
    v_mfma_f32_32x32x16_bf16 v[48:63], v[72:75], v[112:115], v[48:63]
    v_mfma_f32_32x32x16_bf16 v[16:31], v[76:79], v[116:119], v[16:31]
    v_mfma_f32_32x32x16_bf16 v[32:47], v[80:83], v[116:119], v[32:47]
    v_mfma_f32_32x32x16_bf16 v[48:63], v[84:87], v[116:119], v[48:63]
    s_waitcnt vmcnt(4) lgkmcnt(0)
    s_barrier
    s_lshl_b32 s37, s36, 11
    s_add_u32 s37, s37, s25
    s_mul_i32 s38, s36, 88064
    buffer_load_dwordx4 v[112:115], v3, s[8:11], s37 offen
    buffer_load_dwordx4 v[116:119], v3, s[8:11], s37 offen offset:1024
    s_add_u32 m0, s28, 0
    s_add_u32 s38, s38, s26
    buffer_load_dwordx4 v4, s[12:15], s38 offen lds
    s_add_u32 m0, s28, 1024
    s_mov_b64 exec, s[32:33]
    buffer_load_dwordx4 v5, s[12:15], s38 offen lds
    s_mov_b64 exec, s[30:31]
    s_add_u32 s36, s36, 1
    s_and_b32 s36, s36, 15

    ds_read_b64_tr_b16 v[64:65], v12 offset:6144
    ds_read_b64_tr_b16 v[66:67], v12 offset:6912
    ds_read_b64_tr_b16 v[68:69], v12 offset:6208
    ds_read_b64_tr_b16 v[70:71], v12 offset:6976
    ds_read_b64_tr_b16 v[72:73], v12 offset:6272
    ds_read_b64_tr_b16 v[74:75], v12 offset:7040
    ds_read_b64_tr_b16 v[76:77], v12 offset:9216
    ds_read_b64_tr_b16 v[78:79], v12 offset:9984
    ds_read_b64_tr_b16 v[80:81], v12 offset:9280
    ds_read_b64_tr_b16 v[82:83], v12 offset:10048
    ds_read_b64_tr_b16 v[84:85], v12 offset:9344
    ds_read_b64_tr_b16 v[86:87], v12 offset:10112
    v_mfma_f32_32x32x16_bf16 v[16:31], v[88:91], v[120:123], v[16:31]
    v_mfma_f32_32x32x16_bf16 v[32:47], v[92:95], v[120:123], v[32:47]
    v_mfma_f32_32x32x16_bf16 v[48:63], v[96:99], v[120:123], v[48:63]
    v_mfma_f32_32x32x16_bf16 v[16:31], v[100:103], v[124:127], v[16:31]
    v_mfma_f32_32x32x16_bf16 v[32:47], v[104:107], v[124:127], v[32:47]
    v_mfma_f32_32x32x16_bf16 v[48:63], v[108:111], v[124:127], v[48:63]
    s_waitcnt vmcnt(4) lgkmcnt(0)
    s_barrier
    s_lshl_b32 s37, s36, 11
    s_add_u32 s37, s37, s25
    s_mul_i32 s38, s36, 88064
    buffer_load_dwordx4 v[120:123], v3, s[8:11], s37 offen
    buffer_load_dwordx4 v[124:127], v3, s[8:11], s37 offen offset:1024
    s_add_u32 m0, s28, 6144
    s_add_u32 s38, s38, s26
    buffer_load_dwordx4 v4, s[12:15], s38 offen lds
    s_add_u32 m0, s28, 7168
    s_mov_b64 exec, s[32:33]
    buffer_load_dwordx4 v5, s[12:15], s38 offen lds
    s_mov_b64 exec, s[30:31]
    s_add_u32 s36, s36, 1
    s_and_b32 s36, s36, 15

    ds_read_b64_tr_b16 v[88:89], v12 offset:12288
    ds_read_b64_tr_b16 v[90:91], v12 offset:13056
    ds_read_b64_tr_b16 v[92:93], v12 offset:12352
    ds_read_b64_tr_b16 v[94:95], v12 offset:13120
    ds_read_b64_tr_b16 v[96:97], v12 offset:12416
    ds_read_b64_tr_b16 v[98:99], v12 offset:13184
    ds_read_b64_tr_b16 v[100:101], v12 offset:15360
    ds_read_b64_tr_b16 v[102:103], v12 offset:16128
    ds_read_b64_tr_b16 v[104:105], v12 offset:15424
    ds_read_b64_tr_b16 v[106:107], v12 offset:16192
    ds_read_b64_tr_b16 v[108:109], v12 offset:15488
    ds_read_b64_tr_b16 v[110:111], v12 offset:16256
    v_mfma_f32_32x32x16_bf16 v[16:31], v[64:67], v[128:131], v[16:31]
    v_mfma_f32_32x32x16_bf16 v[32:47], v[68:71], v[128:131], v[32:47]
    v_mfma_f32_32x32x16_bf16 v[48:63], v[72:75], v[128:131], v[48:63]
    v_mfma_f32_32x32x16_bf16 v[16:31], v[76:79], v[132:135], v[16:31]
    v_mfma_f32_32x32x16_bf16 v[32:47], v[80:83], v[132:135], v[32:47]
    v_mfma_f32_32x32x16_bf16 v[48:63], v[84:87], v[132:135], v[48:63]
    s_waitcnt vmcnt(4) lgkmcnt(0)
    s_barrier
    s_lshl_b32 s37, s36, 11
    s_add_u32 s37, s37, s25
    s_mul_i32 s38, s36, 88064
    buffer_load_dwordx4 v[128:131], v3, s[8:11], s37 offen
    buffer_load_dwordx4 v[132:135], v3, s[8:11], s37 offen offset:1024
    s_add_u32 m0, s28, 12288
    s_add_u32 s38, s38, s26
    buffer_load_dwordx4 v4, s[12:15], s38 offen lds
    s_add_u32 m0, s28, 13312
    s_mov_b64 exec, s[32:33]
    buffer_load_dwordx4 v5, s[12:15], s38 offen lds
    s_mov_b64 exec, s[30:31]
    s_add_u32 s36, s36, 1
    s_and_b32 s36, s36, 15

    ds_read_b64_tr_b16 v[64:65], v12 offset:0
    ds_read_b64_tr_b16 v[66:67], v12 offset:768
    ds_read_b64_tr_b16 v[68:69], v12 offset:64
    ds_read_b64_tr_b16 v[70:71], v12 offset:832
    ds_read_b64_tr_b16 v[72:73], v12 offset:128
    ds_read_b64_tr_b16 v[74:75], v12 offset:896
    ds_read_b64_tr_b16 v[76:77], v12 offset:3072
    ds_read_b64_tr_b16 v[78:79], v12 offset:3840
    ds_read_b64_tr_b16 v[80:81], v12 offset:3136
    ds_read_b64_tr_b16 v[82:83], v12 offset:3904
    ds_read_b64_tr_b16 v[84:85], v12 offset:3200
    ds_read_b64_tr_b16 v[86:87], v12 offset:3968
    v_mfma_f32_32x32x16_bf16 v[16:31], v[88:91], v[136:139], v[16:31]
    v_mfma_f32_32x32x16_bf16 v[32:47], v[92:95], v[136:139], v[32:47]
    v_mfma_f32_32x32x16_bf16 v[48:63], v[96:99], v[136:139], v[48:63]
    v_mfma_f32_32x32x16_bf16 v[16:31], v[100:103], v[140:143], v[16:31]
    v_mfma_f32_32x32x16_bf16 v[32:47], v[104:107], v[140:143], v[32:47]
    v_mfma_f32_32x32x16_bf16 v[48:63], v[108:111], v[140:143], v[48:63]
    s_waitcnt vmcnt(4) lgkmcnt(0)
    s_barrier
    s_lshl_b32 s37, s36, 11
    s_add_u32 s37, s37, s25
    s_mul_i32 s38, s36, 88064
    buffer_load_dwordx4 v[136:139], v3, s[8:11], s37 offen
    buffer_load_dwordx4 v[140:143], v3, s[8:11], s37 offen offset:1024
    s_add_u32 m0, s28, 0
    s_add_u32 s38, s38, s26
    buffer_load_dwordx4 v4, s[12:15], s38 offen lds
    s_add_u32 m0, s28, 1024
    s_mov_b64 exec, s[32:33]
    buffer_load_dwordx4 v5, s[12:15], s38 offen lds
    s_mov_b64 exec, s[30:31]
    s_add_u32 s36, s36, 1
    s_and_b32 s36, s36, 15

    ds_read_b64_tr_b16 v[88:89], v12 offset:6144
    ds_read_b64_tr_b16 v[90:91], v12 offset:6912
    ds_read_b64_tr_b16 v[92:93], v12 offset:6208
    ds_read_b64_tr_b16 v[94:95], v12 offset:6976
    ds_read_b64_tr_b16 v[96:97], v12 offset:6272
    ds_read_b64_tr_b16 v[98:99], v12 offset:7040
    ds_read_b64_tr_b16 v[100:101], v12 offset:9216
    ds_read_b64_tr_b16 v[102:103], v12 offset:9984
    ds_read_b64_tr_b16 v[104:105], v12 offset:9280
    ds_read_b64_tr_b16 v[106:107], v12 offset:10048
    ds_read_b64_tr_b16 v[108:109], v12 offset:9344
    ds_read_b64_tr_b16 v[110:111], v12 offset:10112
    v_mfma_f32_32x32x16_bf16 v[16:31], v[64:67], v[112:115], v[16:31]
    v_mfma_f32_32x32x16_bf16 v[32:47], v[68:71], v[112:115], v[32:47]
    v_mfma_f32_32x32x16_bf16 v[48:63], v[72:75], v[112:115], v[48:63]
    v_mfma_f32_32x32x16_bf16 v[16:31], v[76:79], v[116:119], v[16:31]
    v_mfma_f32_32x32x16_bf16 v[32:47], v[80:83], v[116:119], v[32:47]
    v_mfma_f32_32x32x16_bf16 v[48:63], v[84:87], v[116:119], v[48:63]
    s_waitcnt vmcnt(4) lgkmcnt(0)
    s_barrier
    ds_read_b64_tr_b16 v[64:65], v12 offset:12288
    ds_read_b64_tr_b16 v[66:67], v12 offset:13056
    ds_read_b64_tr_b16 v[68:69], v12 offset:12352
    ds_read_b64_tr_b16 v[70:71], v12 offset:13120
    ds_read_b64_tr_b16 v[72:73], v12 offset:12416
    ds_read_b64_tr_b16 v[74:75], v12 offset:13184
    ds_read_b64_tr_b16 v[76:77], v12 offset:15360
    ds_read_b64_tr_b16 v[78:79], v12 offset:16128
    ds_read_b64_tr_b16 v[80:81], v12 offset:15424
    ds_read_b64_tr_b16 v[82:83], v12 offset:16192
    ds_read_b64_tr_b16 v[84:85], v12 offset:15488
    ds_read_b64_tr_b16 v[86:87], v12 offset:16256
    v_mfma_f32_32x32x16_bf16 v[16:31], v[88:91], v[120:123], v[16:31]
    v_mfma_f32_32x32x16_bf16 v[32:47], v[92:95], v[120:123], v[32:47]
    v_mfma_f32_32x32x16_bf16 v[48:63], v[96:99], v[120:123], v[48:63]
    v_mfma_f32_32x32x16_bf16 v[16:31], v[100:103], v[124:127], v[16:31]
    v_mfma_f32_32x32x16_bf16 v[32:47], v[104:107], v[124:127], v[32:47]
    v_mfma_f32_32x32x16_bf16 v[48:63], v[108:111], v[124:127], v[48:63]
    s_waitcnt vmcnt(0) lgkmcnt(0)
    s_barrier
    ds_read_b64_tr_b16 v[88:89], v12 offset:0
    ds_read_b64_tr_b16 v[90:91], v12 offset:768
    ds_read_b64_tr_b16 v[92:93], v12 offset:64
    ds_read_b64_tr_b16 v[94:95], v12 offset:832
    ds_read_b64_tr_b16 v[96:97], v12 offset:128
    ds_read_b64_tr_b16 v[98:99], v12 offset:896
    ds_read_b64_tr_b16 v[100:101], v12 offset:3072
    ds_read_b64_tr_b16 v[102:103], v12 offset:3840
    ds_read_b64_tr_b16 v[104:105], v12 offset:3136
    ds_read_b64_tr_b16 v[106:107], v12 offset:3904
    ds_read_b64_tr_b16 v[108:109], v12 offset:3200
    ds_read_b64_tr_b16 v[110:111], v12 offset:3968
    v_mfma_f32_32x32x16_bf16 v[16:31], v[64:67], v[128:131], v[16:31]
    v_mfma_f32_32x32x16_bf16 v[32:47], v[68:71], v[128:131], v[32:47]
    v_mfma_f32_32x32x16_bf16 v[48:63], v[72:75], v[128:131], v[48:63]
    v_mfma_f32_32x32x16_bf16 v[16:31], v[76:79], v[132:135], v[16:31]
    v_mfma_f32_32x32x16_bf16 v[32:47], v[80:83], v[132:135], v[32:47]
    v_mfma_f32_32x32x16_bf16 v[48:63], v[84:87], v[132:135], v[48:63]
    s_waitcnt lgkmcnt(0)
    v_mfma_f32_32x32x16_bf16 v[16:31], v[88:91], v[136:139], v[16:31]
    v_mfma_f32_32x32x16_bf16 v[32:47], v[92:95], v[136:139], v[32:47]
    v_mfma_f32_32x32x16_bf16 v[48:63], v[96:99], v[136:139], v[48:63]
    v_mfma_f32_32x32x16_bf16 v[16:31], v[100:103], v[140:143], v[16:31]
    v_mfma_f32_32x32x16_bf16 v[32:47], v[104:107], v[140:143], v[32:47]
    v_mfma_f32_32x32x16_bf16 v[48:63], v[108:111], v[140:143], v[48:63]
    s_setprio 2
    s_barrier
    s_lshl_b32 s22, s3, 5
    v_add_u32 v8, s22, v6
    v_mul_u32_u24 v8, 208, v8
    v_lshl_add_u32 v8, v7, 3, v8
    s_nop 7
    s_nop 3

    v_max_f32 v16, 0, v16
    v_max_f32 v17, 0, v17
    v_max_f32 v18, 0, v18
    v_max_f32 v19, 0, v19
    v_cvt_pk_bf16_f32 v16, v16, v17
    v_cvt_pk_bf16_f32 v17, v18, v19
    ds_write_b64 v8, v[16:17] offset:0

    v_max_f32 v20, 0, v20
    v_max_f32 v21, 0, v21
    v_max_f32 v22, 0, v22
    v_max_f32 v23, 0, v23
    v_cvt_pk_bf16_f32 v20, v20, v21
    v_cvt_pk_bf16_f32 v21, v22, v23
    ds_write_b64 v8, v[20:21] offset:16

    v_max_f32 v24, 0, v24
    v_max_f32 v25, 0, v25
    v_max_f32 v26, 0, v26
    v_max_f32 v27, 0, v27
    v_cvt_pk_bf16_f32 v24, v24, v25
    v_cvt_pk_bf16_f32 v25, v26, v27
    ds_write_b64 v8, v[24:25] offset:32

    v_max_f32 v28, 0, v28
    v_max_f32 v29, 0, v29
    v_max_f32 v30, 0, v30
    v_max_f32 v31, 0, v31
    v_cvt_pk_bf16_f32 v28, v28, v29
    v_cvt_pk_bf16_f32 v29, v30, v31
    ds_write_b64 v8, v[28:29] offset:48

    v_max_f32 v32, 0, v32
    v_max_f32 v33, 0, v33
    v_max_f32 v34, 0, v34
    v_max_f32 v35, 0, v35
    v_cvt_pk_bf16_f32 v32, v32, v33
    v_cvt_pk_bf16_f32 v33, v34, v35
    ds_write_b64 v8, v[32:33] offset:64

    v_max_f32 v36, 0, v36
    v_max_f32 v37, 0, v37
    v_max_f32 v38, 0, v38
    v_max_f32 v39, 0, v39
    v_cvt_pk_bf16_f32 v36, v36, v37
    v_cvt_pk_bf16_f32 v37, v38, v39
    ds_write_b64 v8, v[36:37] offset:80

    v_max_f32 v40, 0, v40
    v_max_f32 v41, 0, v41
    v_max_f32 v42, 0, v42
    v_max_f32 v43, 0, v43
    v_cvt_pk_bf16_f32 v40, v40, v41
    v_cvt_pk_bf16_f32 v41, v42, v43
    ds_write_b64 v8, v[40:41] offset:96

    v_max_f32 v44, 0, v44
    v_max_f32 v45, 0, v45
    v_max_f32 v46, 0, v46
    v_max_f32 v47, 0, v47
    v_cvt_pk_bf16_f32 v44, v44, v45
    v_cvt_pk_bf16_f32 v45, v46, v47
    ds_write_b64 v8, v[44:45] offset:112

    v_max_f32 v48, 0, v48
    v_max_f32 v49, 0, v49
    v_max_f32 v50, 0, v50
    v_max_f32 v51, 0, v51
    v_cvt_pk_bf16_f32 v48, v48, v49
    v_cvt_pk_bf16_f32 v49, v50, v51
    ds_write_b64 v8, v[48:49] offset:128

    v_max_f32 v52, 0, v52
    v_max_f32 v53, 0, v53
    v_max_f32 v54, 0, v54
    v_max_f32 v55, 0, v55
    v_cvt_pk_bf16_f32 v52, v52, v53
    v_cvt_pk_bf16_f32 v53, v54, v55
    ds_write_b64 v8, v[52:53] offset:144

    v_max_f32 v56, 0, v56
    v_max_f32 v57, 0, v57
    v_max_f32 v58, 0, v58
    v_max_f32 v59, 0, v59
    v_cvt_pk_bf16_f32 v56, v56, v57
    v_cvt_pk_bf16_f32 v57, v58, v59
    ds_write_b64 v8, v[56:57] offset:160

    v_max_f32 v60, 0, v60
    v_max_f32 v61, 0, v61
    v_max_f32 v62, 0, v62
    v_max_f32 v63, 0, v63
    v_cvt_pk_bf16_f32 v60, v60, v61
    v_cvt_pk_bf16_f32 v61, v62, v63
    ds_write_b64 v8, v[60:61] offset:176

    s_mul_i32 s22, s3, 6656
    s_lshl_b32 s25, s20, 2
    s_add_u32 s25, s25, s3
    s_mul_i32 s25, s25, 90112
    s_mul_i32 s26, s21, 6144
    s_add_u32 s25, s25, s26
    v_and_b32 v10, 31, v2
    v_mul_u32_u24 v12, 208, v10
    v_lshrrev_b32 v9, 5, v2
    v_lshl_add_u32 v12, v9, 4, v12
    v_add_u32 v12, s22, v12
    v_lshlrev_b32 v11, 4, v2
    s_mul_i32 s26, s21, 96
    s_movk_i32 s27, 2816
    s_movk_i32 s28, 208
    s_mov_b32 s29, 0x40000000
    s_movk_i32 s34, 1376
    s_movk_i32 s35, 1408
    s_waitcnt lgkmcnt(0)

    ds_read_b128 v[64:67], v12 offset:0
    v_add_u32 v90, 0, v11
    v_add_u32 v10, 0, v9
    v_lshl_add_u32 v96, v10, 3, s26

    ds_read_b128 v[68:71], v12 offset:32
    v_add_u32 v91, 1024, v11
    v_add_u32 v10, 2, v9
    v_lshl_add_u32 v97, v10, 3, s26

    ds_read_b128 v[72:75], v12 offset:64
    v_add_u32 v92, 2048, v11
    v_add_u32 v10, 4, v9
    v_lshl_add_u32 v98, v10, 3, s26

    ds_read_b128 v[76:79], v12 offset:96
    v_add_u32 v93, 3072, v11
    v_add_u32 v10, 6, v9
    v_lshl_add_u32 v99, v10, 3, s26

    ds_read_b128 v[80:83], v12 offset:128
    v_add_u32 v94, 4096, v11
    v_add_u32 v10, 8, v9
    v_lshl_add_u32 v100, v10, 3, s26

    ds_read_b128 v[84:87], v12 offset:160
    v_add_u32 v95, 5120, v11
    v_add_u32 v10, 10, v9
    v_lshl_add_u32 v101, v10, 3, s26

    s_waitcnt lgkmcnt(5)
    v_cmp_gt_u32 vcc, s34, v96
    v_mov_b32 v9, s29
    v_cndmask_b32 v64, 0, v64, vcc
    v_cndmask_b32 v65, 0, v65, vcc
    v_cndmask_b32 v66, 0, v66, vcc
    v_cndmask_b32 v67, 0, v67, vcc
    v_cmp_gt_u32 vcc, s35, v96
    s_nop 1
    v_cndmask_b32 v90, v9, v90, vcc
    buffer_store_dwordx4 v[64:67], v90, s[16:19], s25 offen sc0 sc1

    s_waitcnt lgkmcnt(4)
    v_cmp_gt_u32 vcc, s34, v97
    v_mov_b32 v9, s29
    v_cndmask_b32 v68, 0, v68, vcc
    v_cndmask_b32 v69, 0, v69, vcc
    v_cndmask_b32 v70, 0, v70, vcc
    v_cndmask_b32 v71, 0, v71, vcc
    v_cmp_gt_u32 vcc, s35, v97
    s_nop 1
    v_cndmask_b32 v91, v9, v91, vcc
    buffer_store_dwordx4 v[68:71], v91, s[16:19], s25 offen sc0 sc1

    s_waitcnt lgkmcnt(3)
    v_cmp_gt_u32 vcc, s34, v98
    v_mov_b32 v9, s29
    v_cndmask_b32 v72, 0, v72, vcc
    v_cndmask_b32 v73, 0, v73, vcc
    v_cndmask_b32 v74, 0, v74, vcc
    v_cndmask_b32 v75, 0, v75, vcc
    v_cmp_gt_u32 vcc, s35, v98
    s_nop 1
    v_cndmask_b32 v92, v9, v92, vcc
    buffer_store_dwordx4 v[72:75], v92, s[16:19], s25 offen sc0 sc1

    s_waitcnt lgkmcnt(2)
    v_cmp_gt_u32 vcc, s34, v99
    v_mov_b32 v9, s29
    v_cndmask_b32 v76, 0, v76, vcc
    v_cndmask_b32 v77, 0, v77, vcc
    v_cndmask_b32 v78, 0, v78, vcc
    v_cndmask_b32 v79, 0, v79, vcc
    v_cmp_gt_u32 vcc, s35, v99
    s_nop 1
    v_cndmask_b32 v93, v9, v93, vcc
    buffer_store_dwordx4 v[76:79], v93, s[16:19], s25 offen sc0 sc1

    s_waitcnt lgkmcnt(1)
    v_cmp_gt_u32 vcc, s34, v100
    v_mov_b32 v9, s29
    v_cndmask_b32 v80, 0, v80, vcc
    v_cndmask_b32 v81, 0, v81, vcc
    v_cndmask_b32 v82, 0, v82, vcc
    v_cndmask_b32 v83, 0, v83, vcc
    v_cmp_gt_u32 vcc, s35, v100
    s_nop 1
    v_cndmask_b32 v94, v9, v94, vcc
    buffer_store_dwordx4 v[80:83], v94, s[16:19], s25 offen sc0 sc1

    s_waitcnt lgkmcnt(0)
    v_cmp_gt_u32 vcc, s34, v101
    v_mov_b32 v9, s29
    v_cndmask_b32 v84, 0, v84, vcc
    v_cndmask_b32 v85, 0, v85, vcc
    v_cndmask_b32 v86, 0, v86, vcc
    v_cndmask_b32 v87, 0, v87, vcc
    v_cmp_gt_u32 vcc, s35, v101
    s_nop 1
    v_cndmask_b32 v95, v9, v95, vcc
    buffer_store_dwordx4 v[84:87], v95, s[16:19], s25 offen sc0 sc1

k2_done:
    s_endpgm

.globl k3_kernel
.p2align 8
.type k3_kernel,@function
k3_kernel:
    s_cmp_ge_u32 s2, 512
    s_cbranch_scc1 k3_done
    v_lshrrev_b32 v1, 6, v0
    v_and_b32 v2, 63, v0
    s_load_dwordx2 s[6:7], s[0:1], 112
    v_readfirstlane_b32 s3, v1
    s_cmp_ge_u32 s2, 256
    s_cbranch_scc1 k3_gemm

    s_load_dwordx2 s[4:5], s[0:1], 64
    s_load_dwordx2 s[56:57], s[0:1], 88
    s_add_u32 s20, s2, 256
    v_and_b32 v4, 31, v2
    v_lshrrev_b32 v6, 5, v2
    s_and_b32 s21, s20, 0x1fe
    s_lshl_b32 s21, s21, 1
    s_mul_i32 s23, s20, 4224
    s_add_u32 s26, s23, 48
    s_lshl_b32 s27, s20, 13
    v_lshlrev_b32 v5, 4, v0
    v_lshlrev_b32 v3, 5, v0
    s_waitcnt lgkmcnt(0)
    s_load_dword s22, s[4:5], s21

    s_add_u32 s8, s6, 0x200000
    s_addc_u32 s9, s7, 0
    s_and_b32 s9, s9, 0xffff
    s_mov_b32 s10, 0x211000
    s_mov_b32 s11, 0x00020000

    s_add_u32 s12, s6, 0x620000
    s_addc_u32 s13, s7, 0
    s_and_b32 s13, s13, 0xffff
    s_mov_b32 s14, 0x400000
    s_mov_b32 s15, 0x00020000

    buffer_load_dwordx4 v[32:35], v5, s[8:11], s26 offen
    buffer_load_dwordx4 v[36:39], v5, s[8:11], s26 offen offset:16
    s_add_u32 s28, s27, 0x1000
    buffer_load_dwordx4 v[60:63], v5, s[12:15], s27 offen
    buffer_load_dwordx4 v[64:67], v5, s[12:15], s28 offen

    s_setprio 2
    s_add_u32 s16, s6, 0xa20000
    s_addc_u32 s17, s7, 0
    s_and_b32 s17, s17, 0xffff
    s_mov_b32 s18, 0x200000
    s_mov_b32 s19, 0x00020000

    v_and_b32 v15, 3, v0
    v_mul_u32_u24 v15, 96, v15
    v_lshrrev_b32 v14, 2, v0
    v_add_u32 v15, v15, v14
    v_lshlrev_b32 v15, 4, v15
    v_mov_b32 v20, 0
    v_mov_b32 v21, 0
    v_mov_b32 v22, 0
    v_mov_b32 v23, 0
    s_cmp_eq_u32 s3, 3
    s_cbranch_scc1 k3c_ca_zf
    s_cmp_ge_u32 s3, 2
    s_cbranch_scc1 k3c_ca_nozero
    ds_write_b128 v15, v[20:23] offset:36096
    ds_write_b128 v15, v[20:23] offset:42240
    s_branch k3c_ca_nozero

k3c_ca_zf:
    v_lshrrev_b32 v16, 3, v2
    v_min_u32 v16, 2, v16
    v_lshlrev_b32 v16, 4, v16
    v_and_b32 v17, 7, v2
    v_mov_b32 v18, 4384
    v_mad_u32_u24 v16, v17, v18, v16
    ds_write_b128 v16, v[20:23]

k3c_ca_nozero:
    s_lshl_b32 s35, s3, 4
    v_lshrrev_b32 v12, 3, v4
    v_add_u32 v12, v12, v6
    v_lshlrev_b32 v12, 4, v12
    v_and_b32 v13, 7, v4
    v_mov_b32 v14, 4384
    v_mad_u32_u24 v12, v13, v14, v12
    s_lshl_b32 s36, s35, 5
    v_add_u32 v12, s36, v12
    v_mul_u32_u24 v13, 96, v6
    v_sub_u32 v13, v13, v4
    v_add_u32 v13, 31, v13
    v_lshlrev_b32 v13, 4, v13
    s_lshl_b32 s36, s35, 3
    s_add_u32 s36, s36, 35072
    v_add_u32 v13, s36, v13

    s_waitcnt vmcnt(2)
    ds_write_b128 v5, v[34:37] offset:13200
    ds_write_b128 v5, v[36:39] offset:30736
    v_alignbit_b32 v40, v33, v32, 16
    v_alignbit_b32 v41, v34, v33, 16
    v_alignbit_b32 v42, v35, v34, 16
    v_alignbit_b32 v43, v36, v35, 16
    v_alignbit_b32 v44, v37, v36, 16
    v_alignbit_b32 v45, v38, v37, 16
    ds_write_b128 v5, v[40:43] offset:48
    ds_write_b128 v5, v[42:45] offset:17584
    v_mov_b32 v48, v33
    v_mov_b32 v49, v34
    v_mov_b32 v50, v35
    v_mov_b32 v51, v36
    v_mov_b32 v52, v37
    v_mov_b32 v53, v38
    ds_write_b128 v5, v[48:51] offset:4432
    ds_write_b128 v5, v[50:53] offset:21968
    v_alignbit_b32 v54, v34, v33, 16
    v_alignbit_b32 v55, v35, v34, 16
    v_alignbit_b32 v56, v36, v35, 16
    v_alignbit_b32 v57, v37, v36, 16
    v_alignbit_b32 v58, v38, v37, 16
    v_alignbit_b32 v59, v39, v38, 16
    ds_write_b128 v5, v[54:57] offset:8816
    ds_write_b128 v5, v[56:59] offset:26352
    v_mov_b32 v8, v36
    v_mov_b32 v9, v37
    v_mov_b32 v10, v38
    v_mov_b32 v11, v39
    s_waitcnt vmcnt(1)
    ds_write_b128 v15, v[60:63] offset:35072
    s_waitcnt vmcnt(0)
    ds_write_b128 v15, v[64:67] offset:41216

k3c_cv_join:
    s_waitcnt vmcnt(0) lgkmcnt(0)
    s_barrier

    s_setprio 0
    ds_read_b128 v[80:83], v12 offset:0
    ds_read_b128 v[84:87], v13 offset:0
    ds_read_b128 v[88:91], v13 offset:512
    ds_read_b128 v[92:95], v13 offset:6144
    ds_read_b128 v[96:99], v13 offset:6656
    ds_read_b128 v[100:103], v12 offset:2048
    ds_read_b128 v[104:107], v12 offset:32
    ds_read_b128 v[108:111], v13 offset:3072
    ds_read_b128 v[112:115], v13 offset:3584
    ds_read_b128 v[116:119], v13 offset:9216
    ds_read_b128 v[120:123], v13 offset:9728
    ds_read_b128 v[124:127], v12 offset:2080
    s_waitcnt lgkmcnt(10)
    v_mfma_f32_32x32x16_bf16 v[16:31], v[80:83], v[84:87], 0
    s_waitcnt lgkmcnt(9)
    v_mfma_f32_32x32x16_bf16 v[48:63], v[80:83], v[88:91], 0
    s_waitcnt lgkmcnt(8)
    v_mfma_f32_32x32x16_bf16 v[16:31], v[80:83], v[92:95], v[16:31]
    s_waitcnt lgkmcnt(7)
    v_mfma_f32_32x32x16_bf16 v[48:63], v[80:83], v[96:99], v[48:63]
    s_waitcnt lgkmcnt(6)
    v_mfma_f32_32x32x16_bf16 v[16:31], v[100:103], v[88:91], v[16:31]
    v_mfma_f32_32x32x16_bf16 v[16:31], v[100:103], v[96:99], v[16:31]
    ds_read_b128 v[80:83], v12 offset:64
    ds_read_b128 v[84:87], v13 offset:16
    ds_read_b128 v[88:91], v13 offset:528
    ds_read_b128 v[92:95], v13 offset:6160
    ds_read_b128 v[96:99], v13 offset:6672
    ds_read_b128 v[100:103], v12 offset:2112
    s_waitcnt lgkmcnt(10)
    v_mfma_f32_32x32x16_bf16 v[16:31], v[104:107], v[108:111], v[16:31]
    s_waitcnt lgkmcnt(9)
    v_mfma_f32_32x32x16_bf16 v[48:63], v[104:107], v[112:115], v[48:63]
    s_waitcnt lgkmcnt(8)
    v_mfma_f32_32x32x16_bf16 v[16:31], v[104:107], v[116:119], v[16:31]
    s_waitcnt lgkmcnt(7)
    v_mfma_f32_32x32x16_bf16 v[48:63], v[104:107], v[120:123], v[48:63]
    s_waitcnt lgkmcnt(6)
    v_mfma_f32_32x32x16_bf16 v[16:31], v[124:127], v[112:115], v[16:31]
    v_mfma_f32_32x32x16_bf16 v[16:31], v[124:127], v[120:123], v[16:31]
    ds_read_b128 v[104:107], v12 offset:96
    ds_read_b128 v[108:111], v13 offset:3088
    ds_read_b128 v[112:115], v13 offset:3600
    ds_read_b128 v[116:119], v13 offset:9232
    ds_read_b128 v[120:123], v13 offset:9744
    ds_read_b128 v[124:127], v12 offset:2144
    s_waitcnt lgkmcnt(10)
    v_mfma_f32_32x32x16_bf16 v[16:31], v[80:83], v[84:87], v[16:31]
    s_waitcnt lgkmcnt(9)
    v_mfma_f32_32x32x16_bf16 v[48:63], v[80:83], v[88:91], v[48:63]
    s_waitcnt lgkmcnt(8)
    v_mfma_f32_32x32x16_bf16 v[16:31], v[80:83], v[92:95], v[16:31]
    s_waitcnt lgkmcnt(7)
    v_mfma_f32_32x32x16_bf16 v[48:63], v[80:83], v[96:99], v[48:63]
    s_waitcnt lgkmcnt(6)
    v_mfma_f32_32x32x16_bf16 v[16:31], v[100:103], v[88:91], v[16:31]
    v_mfma_f32_32x32x16_bf16 v[16:31], v[100:103], v[96:99], v[16:31]
    ds_read_b128 v[80:83], v12 offset:128
    ds_read_b128 v[84:87], v13 offset:32
    ds_read_b128 v[88:91], v13 offset:544
    ds_read_b128 v[92:95], v13 offset:6176
    ds_read_b128 v[96:99], v13 offset:6688
    ds_read_b128 v[100:103], v12 offset:2176
    s_waitcnt lgkmcnt(10)
    v_mfma_f32_32x32x16_bf16 v[16:31], v[104:107], v[108:111], v[16:31]
    s_waitcnt lgkmcnt(9)
    v_mfma_f32_32x32x16_bf16 v[48:63], v[104:107], v[112:115], v[48:63]
    s_waitcnt lgkmcnt(8)
    v_mfma_f32_32x32x16_bf16 v[16:31], v[104:107], v[116:119], v[16:31]
    s_waitcnt lgkmcnt(7)
    v_mfma_f32_32x32x16_bf16 v[48:63], v[104:107], v[120:123], v[48:63]
    s_waitcnt lgkmcnt(6)
    v_mfma_f32_32x32x16_bf16 v[16:31], v[124:127], v[112:115], v[16:31]
    v_mfma_f32_32x32x16_bf16 v[16:31], v[124:127], v[120:123], v[16:31]
    ds_read_b128 v[104:107], v12 offset:160
    ds_read_b128 v[108:111], v13 offset:3104
    ds_read_b128 v[112:115], v13 offset:3616
    ds_read_b128 v[116:119], v13 offset:9248
    ds_read_b128 v[120:123], v13 offset:9760
    ds_read_b128 v[124:127], v12 offset:2208
    s_waitcnt lgkmcnt(10)
    v_mfma_f32_32x32x16_bf16 v[16:31], v[80:83], v[84:87], v[16:31]
    s_waitcnt lgkmcnt(9)
    v_mfma_f32_32x32x16_bf16 v[48:63], v[80:83], v[88:91], v[48:63]
    s_waitcnt lgkmcnt(8)
    v_mfma_f32_32x32x16_bf16 v[16:31], v[80:83], v[92:95], v[16:31]
    s_waitcnt lgkmcnt(7)
    v_mfma_f32_32x32x16_bf16 v[48:63], v[80:83], v[96:99], v[48:63]
    s_waitcnt lgkmcnt(6)
    v_mfma_f32_32x32x16_bf16 v[16:31], v[100:103], v[88:91], v[16:31]
    v_mfma_f32_32x32x16_bf16 v[16:31], v[100:103], v[96:99], v[16:31]
    ds_read_b128 v[80:83], v12 offset:192
    ds_read_b128 v[84:87], v13 offset:48
    ds_read_b128 v[88:91], v13 offset:560
    ds_read_b128 v[92:95], v13 offset:6192
    ds_read_b128 v[96:99], v13 offset:6704
    ds_read_b128 v[100:103], v12 offset:2240
    s_waitcnt lgkmcnt(10)
    v_mfma_f32_32x32x16_bf16 v[16:31], v[104:107], v[108:111], v[16:31]
    s_waitcnt lgkmcnt(9)
    v_mfma_f32_32x32x16_bf16 v[48:63], v[104:107], v[112:115], v[48:63]
    s_waitcnt lgkmcnt(8)
    v_mfma_f32_32x32x16_bf16 v[16:31], v[104:107], v[116:119], v[16:31]
    s_waitcnt lgkmcnt(7)
    v_mfma_f32_32x32x16_bf16 v[48:63], v[104:107], v[120:123], v[48:63]
    s_waitcnt lgkmcnt(6)
    v_mfma_f32_32x32x16_bf16 v[16:31], v[124:127], v[112:115], v[16:31]
    v_mfma_f32_32x32x16_bf16 v[16:31], v[124:127], v[120:123], v[16:31]
    ds_read_b128 v[104:107], v12 offset:224
    ds_read_b128 v[108:111], v13 offset:3120
    ds_read_b128 v[112:115], v13 offset:3632
    ds_read_b128 v[116:119], v13 offset:9264
    ds_read_b128 v[120:123], v13 offset:9776
    ds_read_b128 v[124:127], v12 offset:2272
    s_waitcnt lgkmcnt(10)
    v_mfma_f32_32x32x16_bf16 v[16:31], v[80:83], v[84:87], v[16:31]
    s_waitcnt lgkmcnt(9)
    v_mfma_f32_32x32x16_bf16 v[48:63], v[80:83], v[88:91], v[48:63]
    s_waitcnt lgkmcnt(8)
    v_mfma_f32_32x32x16_bf16 v[16:31], v[80:83], v[92:95], v[16:31]
    s_waitcnt lgkmcnt(7)
    v_mfma_f32_32x32x16_bf16 v[48:63], v[80:83], v[96:99], v[48:63]
    s_waitcnt lgkmcnt(6)
    v_mfma_f32_32x32x16_bf16 v[16:31], v[100:103], v[88:91], v[16:31]
    v_mfma_f32_32x32x16_bf16 v[16:31], v[100:103], v[96:99], v[16:31]
    ds_read_b128 v[80:83], v12 offset:256
    ds_read_b128 v[84:87], v13 offset:64
    ds_read_b128 v[88:91], v13 offset:576
    ds_read_b128 v[92:95], v13 offset:6208
    ds_read_b128 v[96:99], v13 offset:6720
    ds_read_b128 v[100:103], v12 offset:2304
    s_waitcnt lgkmcnt(10)
    v_mfma_f32_32x32x16_bf16 v[16:31], v[104:107], v[108:111], v[16:31]
    s_waitcnt lgkmcnt(9)
    v_mfma_f32_32x32x16_bf16 v[48:63], v[104:107], v[112:115], v[48:63]
    s_waitcnt lgkmcnt(8)
    v_mfma_f32_32x32x16_bf16 v[16:31], v[104:107], v[116:119], v[16:31]
    s_waitcnt lgkmcnt(7)
    v_mfma_f32_32x32x16_bf16 v[48:63], v[104:107], v[120:123], v[48:63]
    s_waitcnt lgkmcnt(6)
    v_mfma_f32_32x32x16_bf16 v[16:31], v[124:127], v[112:115], v[16:31]
    v_mfma_f32_32x32x16_bf16 v[16:31], v[124:127], v[120:123], v[16:31]
    ds_read_b128 v[104:107], v12 offset:288
    ds_read_b128 v[108:111], v13 offset:3136
    ds_read_b128 v[112:115], v13 offset:3648
    ds_read_b128 v[116:119], v13 offset:9280
    ds_read_b128 v[120:123], v13 offset:9792
    ds_read_b128 v[124:127], v12 offset:2336
    s_waitcnt lgkmcnt(10)
    v_mfma_f32_32x32x16_bf16 v[16:31], v[80:83], v[84:87], v[16:31]
    s_waitcnt lgkmcnt(9)
    v_mfma_f32_32x32x16_bf16 v[48:63], v[80:83], v[88:91], v[48:63]
    s_waitcnt lgkmcnt(8)
    v_mfma_f32_32x32x16_bf16 v[16:31], v[80:83], v[92:95], v[16:31]
    s_waitcnt lgkmcnt(7)
    v_mfma_f32_32x32x16_bf16 v[48:63], v[80:83], v[96:99], v[48:63]
    s_waitcnt lgkmcnt(6)
    v_mfma_f32_32x32x16_bf16 v[16:31], v[100:103], v[88:91], v[16:31]
    v_mfma_f32_32x32x16_bf16 v[16:31], v[100:103], v[96:99], v[16:31]
    ds_read_b128 v[80:83], v12 offset:320
    ds_read_b128 v[84:87], v13 offset:80
    ds_read_b128 v[88:91], v13 offset:592
    ds_read_b128 v[92:95], v13 offset:6224
    ds_read_b128 v[96:99], v13 offset:6736
    ds_read_b128 v[100:103], v12 offset:2368
    s_waitcnt lgkmcnt(10)
    v_mfma_f32_32x32x16_bf16 v[16:31], v[104:107], v[108:111], v[16:31]
    s_waitcnt lgkmcnt(9)
    v_mfma_f32_32x32x16_bf16 v[48:63], v[104:107], v[112:115], v[48:63]
    s_waitcnt lgkmcnt(8)
    v_mfma_f32_32x32x16_bf16 v[16:31], v[104:107], v[116:119], v[16:31]
    s_waitcnt lgkmcnt(7)
    v_mfma_f32_32x32x16_bf16 v[48:63], v[104:107], v[120:123], v[48:63]
    s_waitcnt lgkmcnt(6)
    v_mfma_f32_32x32x16_bf16 v[16:31], v[124:127], v[112:115], v[16:31]
    v_mfma_f32_32x32x16_bf16 v[16:31], v[124:127], v[120:123], v[16:31]
    ds_read_b128 v[104:107], v12 offset:352
    ds_read_b128 v[108:111], v13 offset:3152
    ds_read_b128 v[112:115], v13 offset:3664
    ds_read_b128 v[116:119], v13 offset:9296
    ds_read_b128 v[120:123], v13 offset:9808
    ds_read_b128 v[124:127], v12 offset:2400
    s_waitcnt lgkmcnt(10)
    v_mfma_f32_32x32x16_bf16 v[16:31], v[80:83], v[84:87], v[16:31]
    s_waitcnt lgkmcnt(9)
    v_mfma_f32_32x32x16_bf16 v[48:63], v[80:83], v[88:91], v[48:63]
    s_waitcnt lgkmcnt(8)
    v_mfma_f32_32x32x16_bf16 v[16:31], v[80:83], v[92:95], v[16:31]
    s_waitcnt lgkmcnt(7)
    v_mfma_f32_32x32x16_bf16 v[48:63], v[80:83], v[96:99], v[48:63]
    s_waitcnt lgkmcnt(6)
    v_mfma_f32_32x32x16_bf16 v[16:31], v[100:103], v[88:91], v[16:31]
    v_mfma_f32_32x32x16_bf16 v[16:31], v[100:103], v[96:99], v[16:31]
    ds_read_b128 v[80:83], v12 offset:384
    ds_read_b128 v[84:87], v13 offset:96
    ds_read_b128 v[88:91], v13 offset:608
    ds_read_b128 v[92:95], v13 offset:6240
    ds_read_b128 v[96:99], v13 offset:6752
    ds_read_b128 v[100:103], v12 offset:2432
    s_waitcnt lgkmcnt(10)
    v_mfma_f32_32x32x16_bf16 v[16:31], v[104:107], v[108:111], v[16:31]
    s_waitcnt lgkmcnt(9)
    v_mfma_f32_32x32x16_bf16 v[48:63], v[104:107], v[112:115], v[48:63]
    s_waitcnt lgkmcnt(8)
    v_mfma_f32_32x32x16_bf16 v[16:31], v[104:107], v[116:119], v[16:31]
    s_waitcnt lgkmcnt(7)
    v_mfma_f32_32x32x16_bf16 v[48:63], v[104:107], v[120:123], v[48:63]
    s_waitcnt lgkmcnt(6)
    v_mfma_f32_32x32x16_bf16 v[16:31], v[124:127], v[112:115], v[16:31]
    v_mfma_f32_32x32x16_bf16 v[16:31], v[124:127], v[120:123], v[16:31]
    ds_read_b128 v[104:107], v12 offset:416
    ds_read_b128 v[108:111], v13 offset:3168
    ds_read_b128 v[112:115], v13 offset:3680
    ds_read_b128 v[116:119], v13 offset:9312
    ds_read_b128 v[120:123], v13 offset:9824
    ds_read_b128 v[124:127], v12 offset:2464
    s_waitcnt lgkmcnt(10)
    v_mfma_f32_32x32x16_bf16 v[16:31], v[80:83], v[84:87], v[16:31]
    s_waitcnt lgkmcnt(9)
    v_mfma_f32_32x32x16_bf16 v[48:63], v[80:83], v[88:91], v[48:63]
    s_waitcnt lgkmcnt(8)
    v_mfma_f32_32x32x16_bf16 v[16:31], v[80:83], v[92:95], v[16:31]
    s_waitcnt lgkmcnt(7)
    v_mfma_f32_32x32x16_bf16 v[48:63], v[80:83], v[96:99], v[48:63]
    s_waitcnt lgkmcnt(6)
    v_mfma_f32_32x32x16_bf16 v[16:31], v[100:103], v[88:91], v[16:31]
    v_mfma_f32_32x32x16_bf16 v[16:31], v[100:103], v[96:99], v[16:31]
    ds_read_b128 v[80:83], v12 offset:448
    ds_read_b128 v[84:87], v13 offset:112
    ds_read_b128 v[88:91], v13 offset:624
    ds_read_b128 v[92:95], v13 offset:6256
    ds_read_b128 v[96:99], v13 offset:6768
    ds_read_b128 v[100:103], v12 offset:2496
    s_waitcnt lgkmcnt(10)
    v_mfma_f32_32x32x16_bf16 v[16:31], v[104:107], v[108:111], v[16:31]
    s_waitcnt lgkmcnt(9)
    v_mfma_f32_32x32x16_bf16 v[48:63], v[104:107], v[112:115], v[48:63]
    s_waitcnt lgkmcnt(8)
    v_mfma_f32_32x32x16_bf16 v[16:31], v[104:107], v[116:119], v[16:31]
    s_waitcnt lgkmcnt(7)
    v_mfma_f32_32x32x16_bf16 v[48:63], v[104:107], v[120:123], v[48:63]
    s_waitcnt lgkmcnt(6)
    v_mfma_f32_32x32x16_bf16 v[16:31], v[124:127], v[112:115], v[16:31]
    v_mfma_f32_32x32x16_bf16 v[16:31], v[124:127], v[120:123], v[16:31]
    ds_read_b128 v[104:107], v12 offset:480
    ds_read_b128 v[108:111], v13 offset:3184
    ds_read_b128 v[112:115], v13 offset:3696
    ds_read_b128 v[116:119], v13 offset:9328
    ds_read_b128 v[120:123], v13 offset:9840
    ds_read_b128 v[124:127], v12 offset:2528
    s_waitcnt lgkmcnt(10)
    v_mfma_f32_32x32x16_bf16 v[16:31], v[80:83], v[84:87], v[16:31]
    s_waitcnt lgkmcnt(9)
    v_mfma_f32_32x32x16_bf16 v[48:63], v[80:83], v[88:91], v[48:63]
    s_waitcnt lgkmcnt(8)
    v_mfma_f32_32x32x16_bf16 v[16:31], v[80:83], v[92:95], v[16:31]
    s_waitcnt lgkmcnt(7)
    v_mfma_f32_32x32x16_bf16 v[48:63], v[80:83], v[96:99], v[48:63]
    s_waitcnt lgkmcnt(6)
    v_mfma_f32_32x32x16_bf16 v[16:31], v[100:103], v[88:91], v[16:31]
    v_mfma_f32_32x32x16_bf16 v[16:31], v[100:103], v[96:99], v[16:31]
    s_waitcnt lgkmcnt(4)
    v_mfma_f32_32x32x16_bf16 v[16:31], v[104:107], v[108:111], v[16:31]
    s_waitcnt lgkmcnt(3)
    v_mfma_f32_32x32x16_bf16 v[48:63], v[104:107], v[112:115], v[48:63]
    s_waitcnt lgkmcnt(2)
    v_mfma_f32_32x32x16_bf16 v[16:31], v[104:107], v[116:119], v[16:31]
    s_waitcnt lgkmcnt(1)
    v_mfma_f32_32x32x16_bf16 v[48:63], v[104:107], v[120:123], v[48:63]
    s_waitcnt lgkmcnt(0)
    v_mfma_f32_32x32x16_bf16 v[16:31], v[124:127], v[112:115], v[16:31]
    v_mfma_f32_32x32x16_bf16 v[16:31], v[124:127], v[120:123], v[16:31]
k3c_cv_fin:
    s_setprio 2
    s_waitcnt lgkmcnt(0)
    s_nop 7
    s_nop 7

    s_barrier
    v_mul_u32_u24 v14, 144, v4
    v_lshl_add_u32 v14, v6, 4, v14
    s_mul_i32 s36, s3, 4608
    v_add_u32 v14, s36, v14

    ds_write_b128 v14, v[16:19] offset:0
    ds_write_b128 v14, v[20:23] offset:32
    ds_write_b128 v14, v[24:27] offset:64
    ds_write_b128 v14, v[28:31] offset:96
    ds_write_b128 v14, v[48:51] offset:18432
    ds_write_b128 v14, v[52:55] offset:18464
    ds_write_b128 v14, v[56:59] offset:18496
    ds_write_b128 v14, v[60:63] offset:18528
    v_lshrrev_b32 v14, 2, v0
    v_and_b32 v14, 31, v14
    v_mul_u32_u24 v14, 144, v14
    v_and_b32 v15, 3, v0
    v_lshl_add_u32 v14, v15, 5, v14
    s_cmp_lt_u32 s3, 2
    s_cselect_b32 s36, 18432, 0
    v_add_u32 v14, s36, v14
    s_waitcnt lgkmcnt(0)
    s_barrier

    ds_read_b128 v[16:19], v14 offset:0
    ds_read_b128 v[20:23], v14 offset:16
    ds_read_b128 v[24:27], v14 offset:4608
    ds_read_b128 v[28:31], v14 offset:4624
    ds_read_b128 v[32:35], v14 offset:9216
    ds_read_b128 v[36:39], v14 offset:9232
    ds_read_b128 v[40:43], v14 offset:13824
    ds_read_b128 v[44:47], v14 offset:13840
    s_waitcnt lgkmcnt(0)
    v_add_f32 v16, v16, v40
    v_add_f32 v17, v17, v41
    v_add_f32 v18, v18, v42
    v_add_f32 v19, v19, v43
    v_add_f32 v20, v20, v44
    v_add_f32 v21, v21, v45
    v_add_f32 v22, v22, v46
    v_add_f32 v23, v23, v47
    s_waitcnt lgkmcnt(0)
    s_and_b32 s21, s20, 1
    s_lshl_b32 s21, s21, 4
    s_lshr_b32 s22, s22, s21
    s_lshl_b32 s22, s22, 16
    s_mov_b32 s23, 0xffff0000
    s_lshl_b32 s24, s20, 12

    v_add_f32 v24, v24, v32
    v_add_f32 v25, v25, v33
    v_add_f32 v26, v26, v34
    v_add_f32 v27, v27, v35
    v_add_f32 v28, v28, v36
    v_add_f32 v29, v29, v37
    v_add_f32 v30, v30, v38
    v_add_f32 v31, v31, v39
    v_add_f32 v16, v16, v24
    v_add_f32 v17, v17, v25
    v_add_f32 v18, v18, v26
    v_add_f32 v19, v19, v27
    v_add_f32 v20, v20, v28
    v_add_f32 v21, v21, v29
    v_add_f32 v22, v22, v30
    v_add_f32 v23, v23, v31
    v_cvt_pk_bf16_f32 v24, v16, v17
    v_lshlrev_b32 v25, 16, v8
    v_and_b32 v26, s23, v8
    v_mul_f32 v25, s22, v25
    v_mul_f32 v26, s22, v26
    v_cvt_pk_bf16_f32 v27, v25, v26
    v_lshlrev_b32 v25, 16, v24
    v_and_b32 v26, s23, v24
    v_lshlrev_b32 v28, 16, v27
    v_and_b32 v29, s23, v27
    v_add_f32 v25, v25, v28
    v_add_f32 v26, v26, v29
    v_cvt_pk_bf16_f32 v32, v25, v26

    v_cvt_pk_bf16_f32 v24, v18, v19
    v_lshlrev_b32 v25, 16, v9
    v_and_b32 v26, s23, v9
    v_mul_f32 v25, s22, v25
    v_mul_f32 v26, s22, v26
    v_cvt_pk_bf16_f32 v27, v25, v26
    v_lshlrev_b32 v25, 16, v24
    v_and_b32 v26, s23, v24
    v_lshlrev_b32 v28, 16, v27
    v_and_b32 v29, s23, v27
    v_add_f32 v25, v25, v28
    v_add_f32 v26, v26, v29
    v_cvt_pk_bf16_f32 v33, v25, v26

    v_cvt_pk_bf16_f32 v24, v20, v21
    v_lshlrev_b32 v25, 16, v10
    v_and_b32 v26, s23, v10
    v_mul_f32 v25, s22, v25
    v_mul_f32 v26, s22, v26
    v_cvt_pk_bf16_f32 v27, v25, v26
    v_lshlrev_b32 v25, 16, v24
    v_and_b32 v26, s23, v24
    v_lshlrev_b32 v28, 16, v27
    v_and_b32 v29, s23, v27
    v_add_f32 v25, v25, v28
    v_add_f32 v26, v26, v29
    v_cvt_pk_bf16_f32 v34, v25, v26

    v_cvt_pk_bf16_f32 v24, v22, v23
    v_lshlrev_b32 v25, 16, v11
    v_and_b32 v26, s23, v11
    v_mul_f32 v25, s22, v25
    v_mul_f32 v26, s22, v26
    v_cvt_pk_bf16_f32 v27, v25, v26
    v_lshlrev_b32 v25, 16, v24
    v_and_b32 v26, s23, v24
    v_lshlrev_b32 v28, 16, v27
    v_and_b32 v29, s23, v27
    v_add_f32 v25, v25, v28
    v_add_f32 v26, v26, v29
    v_cvt_pk_bf16_f32 v35, v25, v26

    buffer_store_dwordx4 v[32:35], v5, s[16:19], s24 offen sc0 sc1

    s_add_u32 s28, s6, 0x420000
    s_addc_u32 s29, s7, 0
    s_and_b32 s29, s29, 0xffff
    s_mov_b32 s30, 0x10000
    s_mov_b32 s31, 0x00020000

    s_lshr_b32 s24, s2, 6
    s_lshl_b32 s24, s24, 8
    s_add_u32 s24, s24, 0x4000
    v_mov_b32 v16, 1
    v_mov_b32 v17, 0
    s_waitcnt vmcnt(0)
    s_barrier
    s_cmp_lg_u32 s3, 0
    s_cbranch_scc1 k3_done
    s_mov_b64 exec, 1
    buffer_atomic_add v16, v17, s[28:31], s24 offen sc0 sc1
    s_mov_b64 exec, -1
    s_lshr_b32 s24, s2, 6
    s_lshl_b32 s24, s24, 12
    s_add_u32 s24, s24, 0x8000
    v_lshlrev_b32 v17, 7, v2
    v_mov_b32 v18, 1
    s_waitcnt vmcnt(0)
    v_readfirstlane_b32 s25, v16
    s_cmp_lg_u32 s25, 63
    s_cbranch_scc1 k3c_notlast
    s_mov_b32 exec_hi, 0
    buffer_store_dword v18, v17, s[28:31], s24 offen sc0 sc1
    s_mov_b32 exec_hi, -1

k3c_notlast:
    s_branch k3_done
k3_gemm:
    s_load_dwordx2 s[4:5], s[0:1], 88
    s_load_dwordx2 s[36:37], s[0:1], 0
    s_load_dwordx2 s[38:39], s[0:1], 96
    s_setprio 0
    s_and_b32 s20, s2, 7
    s_lshl_b32 s20, s20, 1
    s_bfe_u32 s21, s2, 0x10003
    s_add_u32 s20, s20, s21
    s_and_b32 s21, s2, 16
    s_add_u32 s20, s20, s21
    s_bfe_u32 s21, s2, 0x30005
    v_lshlrev_b32 v3, 4, v2
    v_lshrrev_b32 v4, 3, v2
    v_lshlrev_b32 v4, 10, v4
    v_bfe_u32 v5, v2, 4, 1
    v_lshlrev_b32 v5, 2, v5
    v_and_b32 v6, 7, v2
    v_xor_b32 v5, v5, v6
    v_lshl_add_u32 v4, v5, 4, v4
    s_waitcnt lgkmcnt(0)

    s_add_u32 s8, s6, 0xc20000
    s_addc_u32 s9, s7, 0
    s_and_b32 s9, s9, 0xffff
    s_mov_b32 s10, 0x580000
    s_mov_b32 s11, 0x00020000

    s_mov_b32 s12, s4
    s_and_b32 s13, s5, 0xffff
    s_mov_b32 s14, 0x158000
    s_mov_b32 s15, 0x00020000

    s_add_u32 s16, s6, 0xa20000
    s_addc_u32 s17, s7, 0
    s_and_b32 s17, s17, 0xffff
    s_mov_b32 s18, 0x200000
    s_mov_b32 s19, 0x00020000

    s_mov_b32 s40, s36
    s_and_b32 s41, s37, 0xffff
    s_mov_b32 s42, 0x200000
    s_mov_b32 s43, 0x00020000

    s_mov_b32 s44, s38
    s_and_b32 s45, s39, 0xffff
    s_mov_b32 s46, 0x200000
    s_mov_b32 s47, 0x00020000

    s_add_u32 s48, s6, 0x420000
    s_addc_u32 s49, s7, 0
    s_and_b32 s49, s49, 0xffff
    s_mov_b32 s50, 0x10000
    s_mov_b32 s51, 0x00020000

    s_mul_i32 s25, s20, 180224
    s_mul_i32 s26, s3, 22528
    s_add_u32 s25, s25, s26
    s_mul_i32 s26, s3, 360448
    s_lshl_b32 s27, s21, 7
    s_add_u32 s26, s26, s27
    s_lshl_b32 s27, s3, 14

    s_add_u32 s28, s25, 0
    buffer_load_dwordx4 v[144:147], v3, s[8:11], s28 offen
    buffer_load_dwordx4 v[152:155], v3, s[8:11], s28 offen offset:1024

    s_add_u32 s28, s25, 90112
    buffer_load_dwordx4 v[148:151], v3, s[8:11], s28 offen
    buffer_load_dwordx4 v[156:159], v3, s[8:11], s28 offen offset:1024

    s_add_u32 m0, s27, 0
    s_add_u32 s28, s26, 0
    buffer_load_dwordx4 v4, s[12:15], s28 offen lds

    s_add_u32 m0, s27, 1024
    s_add_u32 s28, s26, 8192
    buffer_load_dwordx4 v4, s[12:15], s28 offen lds

    s_add_u32 m0, s27, 2048
    s_add_u32 s28, s26, 16384
    buffer_load_dwordx4 v4, s[12:15], s28 offen lds

    s_add_u32 m0, s27, 3072
    s_add_u32 s28, s26, 24576
    buffer_load_dwordx4 v4, s[12:15], s28 offen lds

    s_add_u32 s28, s25, 2048
    buffer_load_dwordx4 v[160:163], v3, s[8:11], s28 offen
    buffer_load_dwordx4 v[168:171], v3, s[8:11], s28 offen offset:1024

    s_add_u32 s28, s25, 92160
    buffer_load_dwordx4 v[164:167], v3, s[8:11], s28 offen
    buffer_load_dwordx4 v[172:175], v3, s[8:11], s28 offen offset:1024

    s_add_u32 m0, s27, 4096
    s_add_u32 s28, s26, 32768
    buffer_load_dwordx4 v4, s[12:15], s28 offen lds

    s_add_u32 m0, s27, 5120
    s_add_u32 s28, s26, 40960
    buffer_load_dwordx4 v4, s[12:15], s28 offen lds

    s_add_u32 m0, s27, 6144
    s_add_u32 s28, s26, 49152
    buffer_load_dwordx4 v4, s[12:15], s28 offen lds

    s_add_u32 m0, s27, 7168
    s_add_u32 s28, s26, 57344
    buffer_load_dwordx4 v4, s[12:15], s28 offen lds

    s_add_u32 s28, s25, 4096
    buffer_load_dwordx4 v[176:179], v3, s[8:11], s28 offen
    buffer_load_dwordx4 v[184:187], v3, s[8:11], s28 offen offset:1024

    s_add_u32 s28, s25, 94208
    buffer_load_dwordx4 v[180:183], v3, s[8:11], s28 offen
    buffer_load_dwordx4 v[188:191], v3, s[8:11], s28 offen offset:1024

    s_add_u32 m0, s27, 8192
    s_add_u32 s28, s26, 65536
    buffer_load_dwordx4 v4, s[12:15], s28 offen lds

    s_add_u32 m0, s27, 9216
    s_add_u32 s28, s26, 73728
    buffer_load_dwordx4 v4, s[12:15], s28 offen lds

    s_add_u32 m0, s27, 10240
    s_add_u32 s28, s26, 81920
    buffer_load_dwordx4 v4, s[12:15], s28 offen lds

    s_add_u32 m0, s27, 11264
    s_add_u32 s28, s26, 90112
    buffer_load_dwordx4 v4, s[12:15], s28 offen lds

    v_lshrrev_b32 v5, 3, v2
    v_lshlrev_b32 v5, 12, v5
    v_and_b32 v6, 7, v2
    v_lshl_add_u32 v5, v6, 4, v5
    v_lshrrev_b32 v6, 3, v0
    s_lshl_b32 s29, s21, 18
    s_lshl_b32 s30, s20, 7
    s_add_u32 s29, s29, s30
    s_lshl_b32 s30, s3, 16
    s_add_u32 s29, s29, s30
    s_mul_i32 s33, s3, 2080
    s_add_u32 s34, s29, 0x8000
    s_lshl_b32 s35, s21, 12
    s_and_b32 s32, s2, 31
    s_lshl_b32 s32, s32, 7
    s_add_u32 s35, s35, s32
    s_add_u32 s35, s35, 0x4000
    v_mov_b32 v137, 0
    v_lshlrev_b32 v7, 10, v6
    v_and_b32 v8, 7, v0
    v_lshl_add_u32 v7, v8, 4, v7
    s_lshl_b32 s30, s20, 16
    s_lshl_b32 s31, s21, 7
    s_add_u32 s30, s30, s31
    s_add_u32 s24, s30, 0x8000
    buffer_load_dwordx4 v[128:131], v7, s[40:43], s30 offen
    buffer_load_dwordx4 v[132:135], v7, s[40:43], s24 offen

    v_and_b32 v8, 31, v2
    v_lshrrev_b32 v9, 5, v2
    v_lshlrev_b32 v14, 3, v9
    v_bfe_u32 v15, v2, 2, 2
    v_add_u32 v14, v14, v15
    v_lshlrev_b32 v14, 7, v14
    v_bfe_u32 v15, v2, 4, 1
    v_lshl_add_u32 v14, v15, 5, v14
    v_and_b32 v15, 3, v2
    v_lshl_add_u32 v14, v15, 3, v14
    v_bfe_u32 v15, v2, 3, 1
    v_lshl_add_u32 v14, v15, 6, v14
    v_add_u32 v14, s27, v14
    v_xor_b32 v15, 64, v14

    v_mov_b32 v16, 0
    v_mov_b32 v17, 0
    v_mov_b32 v18, 0
    v_mov_b32 v19, 0
    v_mov_b32 v20, 0
    v_mov_b32 v21, 0
    v_mov_b32 v22, 0
    v_mov_b32 v23, 0
    v_mov_b32 v24, 0
    v_mov_b32 v25, 0
    v_mov_b32 v26, 0
    v_mov_b32 v27, 0
    v_mov_b32 v28, 0
    v_mov_b32 v29, 0
    v_mov_b32 v30, 0
    v_mov_b32 v31, 0
    v_mov_b32 v32, 0
    v_mov_b32 v33, 0
    v_mov_b32 v34, 0
    v_mov_b32 v35, 0
    v_mov_b32 v36, 0
    v_mov_b32 v37, 0
    v_mov_b32 v38, 0
    v_mov_b32 v39, 0
    v_mov_b32 v40, 0
    v_mov_b32 v41, 0
    v_mov_b32 v42, 0
    v_mov_b32 v43, 0
    v_mov_b32 v44, 0
    v_mov_b32 v45, 0
    v_mov_b32 v46, 0
    v_mov_b32 v47, 0
    v_mov_b32 v48, 0
    v_mov_b32 v49, 0
    v_mov_b32 v50, 0
    v_mov_b32 v51, 0
    v_mov_b32 v52, 0
    v_mov_b32 v53, 0
    v_mov_b32 v54, 0
    v_mov_b32 v55, 0
    v_mov_b32 v56, 0
    v_mov_b32 v57, 0
    v_mov_b32 v58, 0
    v_mov_b32 v59, 0
    v_mov_b32 v60, 0
    v_mov_b32 v61, 0
    v_mov_b32 v62, 0
    v_mov_b32 v63, 0
    v_mov_b32 v64, 0
    v_mov_b32 v65, 0
    v_mov_b32 v66, 0
    v_mov_b32 v67, 0
    v_mov_b32 v68, 0
    v_mov_b32 v69, 0
    v_mov_b32 v70, 0
    v_mov_b32 v71, 0
    v_mov_b32 v72, 0
    v_mov_b32 v73, 0
    v_mov_b32 v74, 0
    v_mov_b32 v75, 0
    v_mov_b32 v76, 0
    v_mov_b32 v77, 0
    v_mov_b32 v78, 0
    v_mov_b32 v79, 0
    s_waitcnt vmcnt(18)
    ds_read_b64_tr_b16 v[96:97], v14 offset:0
    ds_read_b64_tr_b16 v[98:99], v14 offset:512
    ds_read_b64_tr_b16 v[100:101], v15 offset:0
    ds_read_b64_tr_b16 v[102:103], v15 offset:512
    ds_read_b64_tr_b16 v[104:105], v14 offset:2048
    ds_read_b64_tr_b16 v[106:107], v14 offset:2560
    ds_read_b64_tr_b16 v[108:109], v15 offset:2048
    ds_read_b64_tr_b16 v[110:111], v15 offset:2560
    s_add_u32 s28, s25, 6144
    buffer_load_dwordx4 v[192:195], v3, s[8:11], s28 offen
    buffer_load_dwordx4 v[200:203], v3, s[8:11], s28 offen offset:1024

    s_add_u32 s28, s25, 96256
    buffer_load_dwordx4 v[196:199], v3, s[8:11], s28 offen
    buffer_load_dwordx4 v[204:207], v3, s[8:11], s28 offen offset:1024

    s_add_u32 m0, s27, 12288
    s_add_u32 s28, s26, 98304
    buffer_load_dwordx4 v4, s[12:15], s28 offen lds

    s_add_u32 m0, s27, 13312
    s_add_u32 s28, s26, 106496
    buffer_load_dwordx4 v4, s[12:15], s28 offen lds

    s_add_u32 m0, s27, 14336
    s_add_u32 s28, s26, 114688
    buffer_load_dwordx4 v4, s[12:15], s28 offen lds

    s_add_u32 m0, s27, 15360
    s_add_u32 s28, s26, 122880
    buffer_load_dwordx4 v4, s[12:15], s28 offen lds

    s_waitcnt lgkmcnt(4)
    v_mfma_f32_32x32x16_bf16 v[16:31], v[96:99], v[144:147], v[16:31]
    v_mfma_f32_32x32x16_bf16 v[32:47], v[96:99], v[148:151], v[32:47]
    v_mfma_f32_32x32x16_bf16 v[48:63], v[100:103], v[144:147], v[48:63]
    v_mfma_f32_32x32x16_bf16 v[64:79], v[100:103], v[148:151], v[64:79]
    s_waitcnt lgkmcnt(0)
    v_mfma_f32_32x32x16_bf16 v[16:31], v[104:107], v[152:155], v[16:31]
    v_mfma_f32_32x32x16_bf16 v[32:47], v[104:107], v[156:159], v[32:47]
    v_mfma_f32_32x32x16_bf16 v[48:63], v[108:111], v[152:155], v[48:63]
    v_mfma_f32_32x32x16_bf16 v[64:79], v[108:111], v[156:159], v[64:79]
    s_waitcnt vmcnt(18)
    ds_read_b64_tr_b16 v[96:97], v14 offset:4096
    ds_read_b64_tr_b16 v[98:99], v14 offset:4608
    ds_read_b64_tr_b16 v[100:101], v15 offset:4096
    ds_read_b64_tr_b16 v[102:103], v15 offset:4608
    ds_read_b64_tr_b16 v[104:105], v14 offset:6144
    ds_read_b64_tr_b16 v[106:107], v14 offset:6656
    ds_read_b64_tr_b16 v[108:109], v15 offset:6144
    ds_read_b64_tr_b16 v[110:111], v15 offset:6656
    s_add_u32 s28, s25, 8192
    buffer_load_dwordx4 v[144:147], v3, s[8:11], s28 offen
    buffer_load_dwordx4 v[152:155], v3, s[8:11], s28 offen offset:1024

    s_add_u32 s28, s25, 98304
    buffer_load_dwordx4 v[148:151], v3, s[8:11], s28 offen
    buffer_load_dwordx4 v[156:159], v3, s[8:11], s28 offen offset:1024

    s_add_u32 m0, s27, 0
    s_add_u32 s28, s26, 131072
    buffer_load_dwordx4 v4, s[12:15], s28 offen lds

    s_add_u32 m0, s27, 1024
    s_add_u32 s28, s26, 139264
    buffer_load_dwordx4 v4, s[12:15], s28 offen lds

    s_add_u32 m0, s27, 2048
    s_add_u32 s28, s26, 147456
    buffer_load_dwordx4 v4, s[12:15], s28 offen lds

    s_add_u32 m0, s27, 3072
    s_add_u32 s28, s26, 155648
    buffer_load_dwordx4 v4, s[12:15], s28 offen lds

    s_waitcnt lgkmcnt(4)
    v_mfma_f32_32x32x16_bf16 v[16:31], v[96:99], v[160:163], v[16:31]
    v_mfma_f32_32x32x16_bf16 v[32:47], v[96:99], v[164:167], v[32:47]
    v_mfma_f32_32x32x16_bf16 v[48:63], v[100:103], v[160:163], v[48:63]
    v_mfma_f32_32x32x16_bf16 v[64:79], v[100:103], v[164:167], v[64:79]
    s_waitcnt lgkmcnt(0)
    v_mfma_f32_32x32x16_bf16 v[16:31], v[104:107], v[168:171], v[16:31]
    v_mfma_f32_32x32x16_bf16 v[32:47], v[104:107], v[172:175], v[32:47]
    v_mfma_f32_32x32x16_bf16 v[48:63], v[108:111], v[168:171], v[48:63]
    v_mfma_f32_32x32x16_bf16 v[64:79], v[108:111], v[172:175], v[64:79]
    s_waitcnt vmcnt(18)
    ds_read_b64_tr_b16 v[96:97], v14 offset:8192
    ds_read_b64_tr_b16 v[98:99], v14 offset:8704
    ds_read_b64_tr_b16 v[100:101], v15 offset:8192
    ds_read_b64_tr_b16 v[102:103], v15 offset:8704
    ds_read_b64_tr_b16 v[104:105], v14 offset:10240
    ds_read_b64_tr_b16 v[106:107], v14 offset:10752
    ds_read_b64_tr_b16 v[108:109], v15 offset:10240
    ds_read_b64_tr_b16 v[110:111], v15 offset:10752
    s_add_u32 s28, s25, 10240
    buffer_load_dwordx4 v[160:163], v3, s[8:11], s28 offen
    buffer_load_dwordx4 v[168:171], v3, s[8:11], s28 offen offset:1024

    s_add_u32 s28, s25, 100352
    buffer_load_dwordx4 v[164:167], v3, s[8:11], s28 offen
    buffer_load_dwordx4 v[172:175], v3, s[8:11], s28 offen offset:1024

    s_add_u32 m0, s27, 4096
    s_add_u32 s28, s26, 163840
    buffer_load_dwordx4 v4, s[12:15], s28 offen lds

    s_add_u32 m0, s27, 5120
    s_add_u32 s28, s26, 172032
    buffer_load_dwordx4 v4, s[12:15], s28 offen lds

    s_add_u32 m0, s27, 6144
    s_add_u32 s28, s26, 180224
    buffer_load_dwordx4 v4, s[12:15], s28 offen lds

    s_add_u32 m0, s27, 7168
    s_add_u32 s28, s26, 188416
    buffer_load_dwordx4 v4, s[12:15], s28 offen lds

    s_waitcnt lgkmcnt(4)
    v_mfma_f32_32x32x16_bf16 v[16:31], v[96:99], v[176:179], v[16:31]
    v_mfma_f32_32x32x16_bf16 v[32:47], v[96:99], v[180:183], v[32:47]
    v_mfma_f32_32x32x16_bf16 v[48:63], v[100:103], v[176:179], v[48:63]
    v_mfma_f32_32x32x16_bf16 v[64:79], v[100:103], v[180:183], v[64:79]
    s_waitcnt lgkmcnt(0)
    v_mfma_f32_32x32x16_bf16 v[16:31], v[104:107], v[184:187], v[16:31]
    v_mfma_f32_32x32x16_bf16 v[32:47], v[104:107], v[188:191], v[32:47]
    v_mfma_f32_32x32x16_bf16 v[48:63], v[108:111], v[184:187], v[48:63]
    v_mfma_f32_32x32x16_bf16 v[64:79], v[108:111], v[188:191], v[64:79]
    s_waitcnt vmcnt(16)
    ds_read_b64_tr_b16 v[96:97], v14 offset:12288
    ds_read_b64_tr_b16 v[98:99], v14 offset:12800
    ds_read_b64_tr_b16 v[100:101], v15 offset:12288
    ds_read_b64_tr_b16 v[102:103], v15 offset:12800
    ds_read_b64_tr_b16 v[104:105], v14 offset:14336
    ds_read_b64_tr_b16 v[106:107], v14 offset:14848
    ds_read_b64_tr_b16 v[108:109], v15 offset:14336
    ds_read_b64_tr_b16 v[110:111], v15 offset:14848
    s_add_u32 s28, s25, 12288
    buffer_load_dwordx4 v[176:179], v3, s[8:11], s28 offen
    buffer_load_dwordx4 v[184:187], v3, s[8:11], s28 offen offset:1024

    s_add_u32 s28, s25, 102400
    buffer_load_dwordx4 v[180:183], v3, s[8:11], s28 offen
    buffer_load_dwordx4 v[188:191], v3, s[8:11], s28 offen offset:1024

    s_add_u32 m0, s27, 8192
    s_add_u32 s28, s26, 196608
    buffer_load_dwordx4 v4, s[12:15], s28 offen lds

    s_add_u32 m0, s27, 9216
    s_add_u32 s28, s26, 204800
    buffer_load_dwordx4 v4, s[12:15], s28 offen lds

    s_add_u32 m0, s27, 10240
    s_add_u32 s28, s26, 212992
    buffer_load_dwordx4 v4, s[12:15], s28 offen lds

    s_add_u32 m0, s27, 11264
    s_add_u32 s28, s26, 221184
    buffer_load_dwordx4 v4, s[12:15], s28 offen lds

    s_waitcnt lgkmcnt(4)
    v_mfma_f32_32x32x16_bf16 v[16:31], v[96:99], v[192:195], v[16:31]
    v_mfma_f32_32x32x16_bf16 v[32:47], v[96:99], v[196:199], v[32:47]
    v_mfma_f32_32x32x16_bf16 v[48:63], v[100:103], v[192:195], v[48:63]
    v_mfma_f32_32x32x16_bf16 v[64:79], v[100:103], v[196:199], v[64:79]
    s_waitcnt lgkmcnt(0)
    v_mfma_f32_32x32x16_bf16 v[16:31], v[104:107], v[200:203], v[16:31]
    v_mfma_f32_32x32x16_bf16 v[32:47], v[104:107], v[204:207], v[32:47]
    v_mfma_f32_32x32x16_bf16 v[48:63], v[108:111], v[200:203], v[48:63]
    v_mfma_f32_32x32x16_bf16 v[64:79], v[108:111], v[204:207], v[64:79]
    s_waitcnt vmcnt(16)
    ds_read_b64_tr_b16 v[96:97], v14 offset:0
    ds_read_b64_tr_b16 v[98:99], v14 offset:512
    ds_read_b64_tr_b16 v[100:101], v15 offset:0
    ds_read_b64_tr_b16 v[102:103], v15 offset:512
    ds_read_b64_tr_b16 v[104:105], v14 offset:2048
    ds_read_b64_tr_b16 v[106:107], v14 offset:2560
    ds_read_b64_tr_b16 v[108:109], v15 offset:2048
    ds_read_b64_tr_b16 v[110:111], v15 offset:2560
    s_add_u32 s28, s25, 14336
    buffer_load_dwordx4 v[192:195], v3, s[8:11], s28 offen
    buffer_load_dwordx4 v[200:203], v3, s[8:11], s28 offen offset:1024

    s_add_u32 s28, s25, 104448
    buffer_load_dwordx4 v[196:199], v3, s[8:11], s28 offen
    buffer_load_dwordx4 v[204:207], v3, s[8:11], s28 offen offset:1024

    s_add_u32 m0, s27, 12288
    s_add_u32 s28, s26, 229376
    buffer_load_dwordx4 v4, s[12:15], s28 offen lds

    s_add_u32 m0, s27, 13312
    s_add_u32 s28, s26, 237568
    buffer_load_dwordx4 v4, s[12:15], s28 offen lds

    s_add_u32 m0, s27, 14336
    s_add_u32 s28, s26, 245760
    buffer_load_dwordx4 v4, s[12:15], s28 offen lds

    s_add_u32 m0, s27, 15360
    s_add_u32 s28, s26, 253952
    buffer_load_dwordx4 v4, s[12:15], s28 offen lds

    s_waitcnt lgkmcnt(4)
    v_mfma_f32_32x32x16_bf16 v[16:31], v[96:99], v[144:147], v[16:31]
    v_mfma_f32_32x32x16_bf16 v[32:47], v[96:99], v[148:151], v[32:47]
    v_mfma_f32_32x32x16_bf16 v[48:63], v[100:103], v[144:147], v[48:63]
    v_mfma_f32_32x32x16_bf16 v[64:79], v[100:103], v[148:151], v[64:79]
    s_waitcnt lgkmcnt(0)
    v_mfma_f32_32x32x16_bf16 v[16:31], v[104:107], v[152:155], v[16:31]
    v_mfma_f32_32x32x16_bf16 v[32:47], v[104:107], v[156:159], v[32:47]
    v_mfma_f32_32x32x16_bf16 v[48:63], v[108:111], v[152:155], v[48:63]
    v_mfma_f32_32x32x16_bf16 v[64:79], v[108:111], v[156:159], v[64:79]
    s_waitcnt vmcnt(16)
    ds_read_b64_tr_b16 v[96:97], v14 offset:4096
    ds_read_b64_tr_b16 v[98:99], v14 offset:4608
    ds_read_b64_tr_b16 v[100:101], v15 offset:4096
    ds_read_b64_tr_b16 v[102:103], v15 offset:4608
    ds_read_b64_tr_b16 v[104:105], v14 offset:6144
    ds_read_b64_tr_b16 v[106:107], v14 offset:6656
    ds_read_b64_tr_b16 v[108:109], v15 offset:6144
    ds_read_b64_tr_b16 v[110:111], v15 offset:6656
    s_add_u32 s28, s25, 16384
    buffer_load_dwordx4 v[144:147], v3, s[8:11], s28 offen
    buffer_load_dwordx4 v[152:155], v3, s[8:11], s28 offen offset:1024

    s_add_u32 s28, s25, 106496
    buffer_load_dwordx4 v[148:151], v3, s[8:11], s28 offen
    buffer_load_dwordx4 v[156:159], v3, s[8:11], s28 offen offset:1024

    s_add_u32 m0, s27, 0
    s_add_u32 s28, s26, 262144
    buffer_load_dwordx4 v4, s[12:15], s28 offen lds

    s_add_u32 m0, s27, 1024
    s_add_u32 s28, s26, 270336
    buffer_load_dwordx4 v4, s[12:15], s28 offen lds

    s_add_u32 m0, s27, 2048
    s_add_u32 s28, s26, 278528
    buffer_load_dwordx4 v4, s[12:15], s28 offen lds

    s_add_u32 m0, s27, 3072
    s_add_u32 s28, s26, 286720
    buffer_load_dwordx4 v4, s[12:15], s28 offen lds

    s_waitcnt lgkmcnt(4)
    v_mfma_f32_32x32x16_bf16 v[16:31], v[96:99], v[160:163], v[16:31]
    v_mfma_f32_32x32x16_bf16 v[32:47], v[96:99], v[164:167], v[32:47]
    v_mfma_f32_32x32x16_bf16 v[48:63], v[100:103], v[160:163], v[48:63]
    v_mfma_f32_32x32x16_bf16 v[64:79], v[100:103], v[164:167], v[64:79]
    s_waitcnt lgkmcnt(0)
    v_mfma_f32_32x32x16_bf16 v[16:31], v[104:107], v[168:171], v[16:31]
    v_mfma_f32_32x32x16_bf16 v[32:47], v[104:107], v[172:175], v[32:47]
    v_mfma_f32_32x32x16_bf16 v[48:63], v[108:111], v[168:171], v[48:63]
    v_mfma_f32_32x32x16_bf16 v[64:79], v[108:111], v[172:175], v[64:79]
    s_waitcnt vmcnt(16)
    ds_read_b64_tr_b16 v[96:97], v14 offset:8192
    ds_read_b64_tr_b16 v[98:99], v14 offset:8704
    ds_read_b64_tr_b16 v[100:101], v15 offset:8192
    ds_read_b64_tr_b16 v[102:103], v15 offset:8704
    ds_read_b64_tr_b16 v[104:105], v14 offset:10240
    ds_read_b64_tr_b16 v[106:107], v14 offset:10752
    ds_read_b64_tr_b16 v[108:109], v15 offset:10240
    ds_read_b64_tr_b16 v[110:111], v15 offset:10752
    s_add_u32 s28, s25, 18432
    buffer_load_dwordx4 v[160:163], v3, s[8:11], s28 offen
    buffer_load_dwordx4 v[168:171], v3, s[8:11], s28 offen offset:1024

    s_add_u32 s28, s25, 108544
    buffer_load_dwordx4 v[164:167], v3, s[8:11], s28 offen
    buffer_load_dwordx4 v[172:175], v3, s[8:11], s28 offen offset:1024

    s_add_u32 m0, s27, 4096
    s_add_u32 s28, s26, 294912
    buffer_load_dwordx4 v4, s[12:15], s28 offen lds

    s_add_u32 m0, s27, 5120
    s_add_u32 s28, s26, 303104
    buffer_load_dwordx4 v4, s[12:15], s28 offen lds

    s_add_u32 m0, s27, 6144
    s_add_u32 s28, s26, 311296
    buffer_load_dwordx4 v4, s[12:15], s28 offen lds

    s_add_u32 m0, s27, 7168
    s_add_u32 s28, s26, 319488
    buffer_load_dwordx4 v4, s[12:15], s28 offen lds

    s_waitcnt lgkmcnt(4)
    v_mfma_f32_32x32x16_bf16 v[16:31], v[96:99], v[176:179], v[16:31]
    v_mfma_f32_32x32x16_bf16 v[32:47], v[96:99], v[180:183], v[32:47]
    v_mfma_f32_32x32x16_bf16 v[48:63], v[100:103], v[176:179], v[48:63]
    v_mfma_f32_32x32x16_bf16 v[64:79], v[100:103], v[180:183], v[64:79]
    s_waitcnt lgkmcnt(0)
    v_mfma_f32_32x32x16_bf16 v[16:31], v[104:107], v[184:187], v[16:31]
    v_mfma_f32_32x32x16_bf16 v[32:47], v[104:107], v[188:191], v[32:47]
    v_mfma_f32_32x32x16_bf16 v[48:63], v[108:111], v[184:187], v[48:63]
    v_mfma_f32_32x32x16_bf16 v[64:79], v[108:111], v[188:191], v[64:79]
    s_waitcnt vmcnt(16)
    ds_read_b64_tr_b16 v[96:97], v14 offset:12288
    ds_read_b64_tr_b16 v[98:99], v14 offset:12800
    ds_read_b64_tr_b16 v[100:101], v15 offset:12288
    ds_read_b64_tr_b16 v[102:103], v15 offset:12800
    ds_read_b64_tr_b16 v[104:105], v14 offset:14336
    ds_read_b64_tr_b16 v[106:107], v14 offset:14848
    ds_read_b64_tr_b16 v[108:109], v15 offset:14336
    ds_read_b64_tr_b16 v[110:111], v15 offset:14848
    s_add_u32 s28, s25, 20480
    buffer_load_dwordx4 v[176:179], v3, s[8:11], s28 offen
    buffer_load_dwordx4 v[184:187], v3, s[8:11], s28 offen offset:1024

    s_add_u32 s28, s25, 110592
    buffer_load_dwordx4 v[180:183], v3, s[8:11], s28 offen
    buffer_load_dwordx4 v[188:191], v3, s[8:11], s28 offen offset:1024

    s_add_u32 m0, s27, 8192
    s_add_u32 s28, s26, 327680
    buffer_load_dwordx4 v4, s[12:15], s28 offen lds

    s_add_u32 m0, s27, 9216
    s_add_u32 s28, s26, 335872
    buffer_load_dwordx4 v4, s[12:15], s28 offen lds

    s_add_u32 m0, s27, 10240
    s_add_u32 s28, s26, 344064
    buffer_load_dwordx4 v4, s[12:15], s28 offen lds

    s_add_u32 m0, s27, 11264
    s_add_u32 s28, s26, 352256
    buffer_load_dwordx4 v4, s[12:15], s28 offen lds

    s_waitcnt lgkmcnt(4)
    v_mfma_f32_32x32x16_bf16 v[16:31], v[96:99], v[192:195], v[16:31]
    v_mfma_f32_32x32x16_bf16 v[32:47], v[96:99], v[196:199], v[32:47]
    v_mfma_f32_32x32x16_bf16 v[48:63], v[100:103], v[192:195], v[48:63]
    v_mfma_f32_32x32x16_bf16 v[64:79], v[100:103], v[196:199], v[64:79]
    s_waitcnt lgkmcnt(0)
    v_mfma_f32_32x32x16_bf16 v[16:31], v[104:107], v[200:203], v[16:31]
    v_mfma_f32_32x32x16_bf16 v[32:47], v[104:107], v[204:207], v[32:47]
    v_mfma_f32_32x32x16_bf16 v[48:63], v[108:111], v[200:203], v[48:63]
    v_mfma_f32_32x32x16_bf16 v[64:79], v[108:111], v[204:207], v[64:79]
    s_waitcnt vmcnt(16)
    ds_read_b64_tr_b16 v[96:97], v14 offset:0
    ds_read_b64_tr_b16 v[98:99], v14 offset:512
    ds_read_b64_tr_b16 v[100:101], v15 offset:0
    ds_read_b64_tr_b16 v[102:103], v15 offset:512
    ds_read_b64_tr_b16 v[104:105], v14 offset:2048
    ds_read_b64_tr_b16 v[106:107], v14 offset:2560
    ds_read_b64_tr_b16 v[108:109], v15 offset:2048
    ds_read_b64_tr_b16 v[110:111], v15 offset:2560
    s_waitcnt lgkmcnt(4)
    v_mfma_f32_32x32x16_bf16 v[16:31], v[96:99], v[144:147], v[16:31]
    v_mfma_f32_32x32x16_bf16 v[32:47], v[96:99], v[148:151], v[32:47]
    v_mfma_f32_32x32x16_bf16 v[48:63], v[100:103], v[144:147], v[48:63]
    v_mfma_f32_32x32x16_bf16 v[64:79], v[100:103], v[148:151], v[64:79]
    s_waitcnt lgkmcnt(0)
    v_mfma_f32_32x32x16_bf16 v[16:31], v[104:107], v[152:155], v[16:31]
    v_mfma_f32_32x32x16_bf16 v[32:47], v[104:107], v[156:159], v[32:47]
    v_mfma_f32_32x32x16_bf16 v[48:63], v[108:111], v[152:155], v[48:63]
    v_mfma_f32_32x32x16_bf16 v[64:79], v[108:111], v[156:159], v[64:79]
    s_cmp_lt_u32 s21, 4
    s_cbranch_scc1 k3_ready
    s_mov_b32 s31, 0x40000

k3_poll:
    buffer_load_dword v136, v137, s[48:51], s35 offen sc0 sc1
    s_sub_u32 s31, s31, 1
    s_waitcnt vmcnt(0)
    v_readfirstlane_b32 s32, v136
    s_cmp_eq_u32 s31, 0
    s_cbranch_scc1 k3_ready
    s_cmp_eq_u32 s32, 1
    s_cbranch_scc1 k3_ready
    s_sleep 4
    s_branch k3_poll

k3_ready:
    s_add_u32 m0, s33, 69632
    s_nop 0
    buffer_load_dwordx4 v5, s[16:19], s29 offen sc0 sc1 lds
    s_add_u32 m0, s33, 70656
    s_nop 0
    buffer_load_dwordx4 v5, s[16:19], s34 offen sc0 sc1 lds

    s_waitcnt vmcnt(10)
    ds_read_b64_tr_b16 v[96:97], v14 offset:4096
    ds_read_b64_tr_b16 v[98:99], v14 offset:4608
    ds_read_b64_tr_b16 v[100:101], v15 offset:4096
    ds_read_b64_tr_b16 v[102:103], v15 offset:4608
    ds_read_b64_tr_b16 v[104:105], v14 offset:6144
    ds_read_b64_tr_b16 v[106:107], v14 offset:6656
    ds_read_b64_tr_b16 v[108:109], v15 offset:6144
    ds_read_b64_tr_b16 v[110:111], v15 offset:6656
    s_waitcnt lgkmcnt(4)
    v_mfma_f32_32x32x16_bf16 v[16:31], v[96:99], v[160:163], v[16:31]
    v_mfma_f32_32x32x16_bf16 v[32:47], v[96:99], v[164:167], v[32:47]
    v_mfma_f32_32x32x16_bf16 v[48:63], v[100:103], v[160:163], v[48:63]
    v_mfma_f32_32x32x16_bf16 v[64:79], v[100:103], v[164:167], v[64:79]
    s_waitcnt lgkmcnt(0)
    v_mfma_f32_32x32x16_bf16 v[16:31], v[104:107], v[168:171], v[16:31]
    v_mfma_f32_32x32x16_bf16 v[32:47], v[104:107], v[172:175], v[32:47]
    v_mfma_f32_32x32x16_bf16 v[48:63], v[108:111], v[168:171], v[48:63]
    v_mfma_f32_32x32x16_bf16 v[64:79], v[108:111], v[172:175], v[64:79]
    s_waitcnt vmcnt(2)
    ds_read_b64_tr_b16 v[96:97], v14 offset:8192
    ds_read_b64_tr_b16 v[98:99], v14 offset:8704
    ds_read_b64_tr_b16 v[100:101], v15 offset:8192
    ds_read_b64_tr_b16 v[102:103], v15 offset:8704
    ds_read_b64_tr_b16 v[104:105], v14 offset:10240
    ds_read_b64_tr_b16 v[106:107], v14 offset:10752
    ds_read_b64_tr_b16 v[108:109], v15 offset:10240
    ds_read_b64_tr_b16 v[110:111], v15 offset:10752
    s_waitcnt lgkmcnt(4)
    v_mfma_f32_32x32x16_bf16 v[16:31], v[96:99], v[176:179], v[16:31]
    v_mfma_f32_32x32x16_bf16 v[32:47], v[96:99], v[180:183], v[32:47]
    v_mfma_f32_32x32x16_bf16 v[48:63], v[100:103], v[176:179], v[48:63]
    v_mfma_f32_32x32x16_bf16 v[64:79], v[100:103], v[180:183], v[64:79]
    s_waitcnt lgkmcnt(0)
    v_mfma_f32_32x32x16_bf16 v[16:31], v[104:107], v[184:187], v[16:31]
    v_mfma_f32_32x32x16_bf16 v[32:47], v[104:107], v[188:191], v[32:47]
    v_mfma_f32_32x32x16_bf16 v[48:63], v[108:111], v[184:187], v[48:63]
    v_mfma_f32_32x32x16_bf16 v[64:79], v[108:111], v[188:191], v[64:79]
    s_barrier
    v_mul_u32_u24 v10, 272, v8
    v_lshl_add_u32 v10, v9, 4, v10
    s_mul_i32 s28, s3, 17408
    v_add_u32 v10, s28, v10
    s_nop 7
    s_nop 3

    ds_write_b128 v10, v[16:19] offset:0
    ds_write_b128 v10, v[20:23] offset:32
    ds_write_b128 v10, v[24:27] offset:64
    ds_write_b128 v10, v[28:31] offset:96
    ds_write_b128 v10, v[32:35] offset:8704
    ds_write_b128 v10, v[36:39] offset:8736
    ds_write_b128 v10, v[40:43] offset:8768
    ds_write_b128 v10, v[44:47] offset:8800
    ds_write_b128 v10, v[48:51] offset:128
    ds_write_b128 v10, v[52:55] offset:160
    ds_write_b128 v10, v[56:59] offset:192
    ds_write_b128 v10, v[60:63] offset:224
    ds_write_b128 v10, v[64:67] offset:8832
    ds_write_b128 v10, v[68:71] offset:8864
    ds_write_b128 v10, v[72:75] offset:8896
    ds_write_b128 v10, v[76:79] offset:8928
    v_mul_u32_u24 v11, 272, v6
    v_and_b32 v12, 7, v0
    v_lshl_add_u32 v11, v12, 5, v11
    v_bfe_u32 v13, v0, 1, 2
    v_mul_u32_u24 v13, 2080, v13
    v_and_b32 v12, 1, v0
    v_lshl_add_u32 v12, v12, 10, v13
    v_lshl_add_u32 v12, v6, 1, v12
    v_add_u32 v12, 69632, v12
    s_mov_b32 s23, 0xffff0000
    s_waitcnt vmcnt(0) lgkmcnt(0)
    s_barrier

    ds_read_b128 v[16:19], v11 offset:0
    ds_read_b128 v[20:23], v11 offset:16
    ds_read_b128 v[24:27], v11 offset:8704
    ds_read_b128 v[28:31], v11 offset:8720
    ds_read_b128 v[32:35], v11 offset:17408
    ds_read_b128 v[36:39], v11 offset:17424
    ds_read_b128 v[40:43], v11 offset:26112
    ds_read_b128 v[44:47], v11 offset:26128
    ds_read_b128 v[48:51], v11 offset:34816
    ds_read_b128 v[52:55], v11 offset:34832
    ds_read_b128 v[56:59], v11 offset:43520
    ds_read_b128 v[60:63], v11 offset:43536
    ds_read_b128 v[64:67], v11 offset:52224
    ds_read_b128 v[68:71], v11 offset:52240
    ds_read_b128 v[72:75], v11 offset:60928
    ds_read_b128 v[76:79], v11 offset:60944
    s_waitcnt lgkmcnt(8)
    v_add_f32 v16, v16, v32
    v_add_f32 v17, v17, v33
    v_add_f32 v18, v18, v34
    v_add_f32 v19, v19, v35
    v_add_f32 v20, v20, v36
    v_add_f32 v21, v21, v37
    v_add_f32 v22, v22, v38
    v_add_f32 v23, v23, v39
    v_add_f32 v24, v24, v40
    v_add_f32 v25, v25, v41
    v_add_f32 v26, v26, v42
    v_add_f32 v27, v27, v43
    v_add_f32 v28, v28, v44
    v_add_f32 v29, v29, v45
    v_add_f32 v30, v30, v46
    v_add_f32 v31, v31, v47
    s_waitcnt lgkmcnt(0)
    ds_read_u16 v112, v12 offset:0
    ds_read_u16 v113, v12 offset:128
    ds_read_u16 v114, v12 offset:256
    ds_read_u16 v115, v12 offset:384
    ds_read_u16 v116, v12 offset:512
    ds_read_u16 v117, v12 offset:640
    ds_read_u16 v118, v12 offset:768
    ds_read_u16 v119, v12 offset:896
    ds_read_u16 v120, v12 offset:64
    ds_read_u16 v121, v12 offset:192
    ds_read_u16 v122, v12 offset:320
    ds_read_u16 v123, v12 offset:448
    ds_read_u16 v124, v12 offset:576
    ds_read_u16 v125, v12 offset:704
    ds_read_u16 v126, v12 offset:832
    ds_read_u16 v127, v12 offset:960
    v_add_f32 v48, v48, v64
    v_add_f32 v49, v49, v65
    v_add_f32 v50, v50, v66
    v_add_f32 v51, v51, v67
    v_add_f32 v52, v52, v68
    v_add_f32 v53, v53, v69
    v_add_f32 v54, v54, v70
    v_add_f32 v55, v55, v71
    v_add_f32 v56, v56, v72
    v_add_f32 v57, v57, v73
    v_add_f32 v58, v58, v74
    v_add_f32 v59, v59, v75
    v_add_f32 v60, v60, v76
    v_add_f32 v61, v61, v77
    v_add_f32 v62, v62, v78
    v_add_f32 v63, v63, v79
    v_add_f32 v16, v16, v48
    v_add_f32 v17, v17, v49
    v_add_f32 v18, v18, v50
    v_add_f32 v19, v19, v51
    v_add_f32 v20, v20, v52
    v_add_f32 v21, v21, v53
    v_add_f32 v22, v22, v54
    v_add_f32 v23, v23, v55
    v_add_f32 v24, v24, v56
    v_add_f32 v25, v25, v57
    v_add_f32 v26, v26, v58
    v_add_f32 v27, v27, v59
    v_add_f32 v28, v28, v60
    v_add_f32 v29, v29, v61
    v_add_f32 v30, v30, v62
    v_add_f32 v31, v31, v63
    s_waitcnt vmcnt(0) lgkmcnt(0)
    v_cvt_pk_bf16_f32 v32, v16, v17
    v_lshlrev_b32 v33, 16, v128
    v_and_b32 v34, s23, v128
    v_lshlrev_b32 v35, 16, v112
    v_lshlrev_b32 v36, 16, v113
    v_add_f32 v33, v33, v35
    v_add_f32 v34, v34, v36
    v_cvt_pk_bf16_f32 v33, v33, v34
    v_lshlrev_b32 v35, 16, v32
    v_and_b32 v36, s23, v32
    v_lshlrev_b32 v37, 16, v33
    v_and_b32 v38, s23, v33
    v_add_f32 v35, v35, v37
    v_add_f32 v36, v36, v38
    v_cvt_pk_bf16_f32 v40, v35, v36

    v_cvt_pk_bf16_f32 v32, v18, v19
    v_lshlrev_b32 v33, 16, v129
    v_and_b32 v34, s23, v129
    v_lshlrev_b32 v35, 16, v114
    v_lshlrev_b32 v36, 16, v115
    v_add_f32 v33, v33, v35
    v_add_f32 v34, v34, v36
    v_cvt_pk_bf16_f32 v33, v33, v34
    v_lshlrev_b32 v35, 16, v32
    v_and_b32 v36, s23, v32
    v_lshlrev_b32 v37, 16, v33
    v_and_b32 v38, s23, v33
    v_add_f32 v35, v35, v37
    v_add_f32 v36, v36, v38
    v_cvt_pk_bf16_f32 v41, v35, v36

    v_cvt_pk_bf16_f32 v32, v20, v21
    v_lshlrev_b32 v33, 16, v130
    v_and_b32 v34, s23, v130
    v_lshlrev_b32 v35, 16, v116
    v_lshlrev_b32 v36, 16, v117
    v_add_f32 v33, v33, v35
    v_add_f32 v34, v34, v36
    v_cvt_pk_bf16_f32 v33, v33, v34
    v_lshlrev_b32 v35, 16, v32
    v_and_b32 v36, s23, v32
    v_lshlrev_b32 v37, 16, v33
    v_and_b32 v38, s23, v33
    v_add_f32 v35, v35, v37
    v_add_f32 v36, v36, v38
    v_cvt_pk_bf16_f32 v42, v35, v36

    v_cvt_pk_bf16_f32 v32, v22, v23
    v_lshlrev_b32 v33, 16, v131
    v_and_b32 v34, s23, v131
    v_lshlrev_b32 v35, 16, v118
    v_lshlrev_b32 v36, 16, v119
    v_add_f32 v33, v33, v35
    v_add_f32 v34, v34, v36
    v_cvt_pk_bf16_f32 v33, v33, v34
    v_lshlrev_b32 v35, 16, v32
    v_and_b32 v36, s23, v32
    v_lshlrev_b32 v37, 16, v33
    v_and_b32 v38, s23, v33
    v_add_f32 v35, v35, v37
    v_add_f32 v36, v36, v38
    v_cvt_pk_bf16_f32 v43, v35, v36

    v_cvt_pk_bf16_f32 v32, v24, v25
    v_lshlrev_b32 v33, 16, v132
    v_and_b32 v34, s23, v132
    v_lshlrev_b32 v35, 16, v120
    v_lshlrev_b32 v36, 16, v121
    v_add_f32 v33, v33, v35
    v_add_f32 v34, v34, v36
    v_cvt_pk_bf16_f32 v33, v33, v34
    v_lshlrev_b32 v35, 16, v32
    v_and_b32 v36, s23, v32
    v_lshlrev_b32 v37, 16, v33
    v_and_b32 v38, s23, v33
    v_add_f32 v35, v35, v37
    v_add_f32 v36, v36, v38
    v_cvt_pk_bf16_f32 v44, v35, v36

    v_cvt_pk_bf16_f32 v32, v26, v27
    v_lshlrev_b32 v33, 16, v133
    v_and_b32 v34, s23, v133
    v_lshlrev_b32 v35, 16, v122
    v_lshlrev_b32 v36, 16, v123
    v_add_f32 v33, v33, v35
    v_add_f32 v34, v34, v36
    v_cvt_pk_bf16_f32 v33, v33, v34
    v_lshlrev_b32 v35, 16, v32
    v_and_b32 v36, s23, v32
    v_lshlrev_b32 v37, 16, v33
    v_and_b32 v38, s23, v33
    v_add_f32 v35, v35, v37
    v_add_f32 v36, v36, v38
    v_cvt_pk_bf16_f32 v45, v35, v36

    v_cvt_pk_bf16_f32 v32, v28, v29
    v_lshlrev_b32 v33, 16, v134
    v_and_b32 v34, s23, v134
    v_lshlrev_b32 v35, 16, v124
    v_lshlrev_b32 v36, 16, v125
    v_add_f32 v33, v33, v35
    v_add_f32 v34, v34, v36
    v_cvt_pk_bf16_f32 v33, v33, v34
    v_lshlrev_b32 v35, 16, v32
    v_and_b32 v36, s23, v32
    v_lshlrev_b32 v37, 16, v33
    v_and_b32 v38, s23, v33
    v_add_f32 v35, v35, v37
    v_add_f32 v36, v36, v38
    v_cvt_pk_bf16_f32 v46, v35, v36

    v_cvt_pk_bf16_f32 v32, v30, v31
    v_lshlrev_b32 v33, 16, v135
    v_and_b32 v34, s23, v135
    v_lshlrev_b32 v35, 16, v126
    v_lshlrev_b32 v36, 16, v127
    v_add_f32 v33, v33, v35
    v_add_f32 v34, v34, v36
    v_cvt_pk_bf16_f32 v33, v33, v34
    v_lshlrev_b32 v35, 16, v32
    v_and_b32 v36, s23, v32
    v_lshlrev_b32 v37, 16, v33
    v_and_b32 v38, s23, v33
    v_add_f32 v35, v35, v37
    v_add_f32 v36, v36, v38
    v_cvt_pk_bf16_f32 v47, v35, v36

    buffer_store_dwordx4 v[40:43], v7, s[44:47], s30 offen sc0 sc1
    buffer_store_dwordx4 v[44:47], v7, s[44:47], s24 offen sc0 sc1

k3_done:
    s_endpgm

.section .rodata,"a"
.p2align 6
.amdhsa_kernel k1_kernel
  .amdhsa_next_free_vgpr 128
  .amdhsa_next_free_sgpr 102
  .amdhsa_accum_offset 128
  .amdhsa_group_segment_fixed_size 0
  .amdhsa_kernarg_size 120
  .amdhsa_user_sgpr_count 2
  .amdhsa_user_sgpr_kernarg_segment_ptr 1
  .amdhsa_system_sgpr_workgroup_id_x 1
  .amdhsa_float_denorm_mode_32 3
.end_amdhsa_kernel

.p2align 6
.amdhsa_kernel k2_kernel
  .amdhsa_next_free_vgpr 144
  .amdhsa_next_free_sgpr 102
  .amdhsa_accum_offset 144
  .amdhsa_group_segment_fixed_size 0
  .amdhsa_kernarg_size 120
  .amdhsa_user_sgpr_count 2
  .amdhsa_user_sgpr_kernarg_segment_ptr 1
  .amdhsa_system_sgpr_workgroup_id_x 1
  .amdhsa_float_denorm_mode_32 3
.end_amdhsa_kernel

.p2align 6
.amdhsa_kernel k3_kernel
  .amdhsa_next_free_vgpr 208
  .amdhsa_next_free_sgpr 102
  .amdhsa_accum_offset 208
  .amdhsa_group_segment_fixed_size 0
  .amdhsa_kernarg_size 120
  .amdhsa_user_sgpr_count 2
  .amdhsa_user_sgpr_kernarg_segment_ptr 1
  .amdhsa_system_sgpr_workgroup_id_x 1
  .amdhsa_float_denorm_mode_32 3
.end_amdhsa_kernel
```
